```python
import torch

def _softmax(x, axis=-1):
    return torch.softmax(x, dim=axis)
def _gelu(x):
    return torch.nn.functional.gelu(x, approximate="tanh")
def _silu(x):
    return torch.nn.functional.silu(x)
def _sigmoid(x):
    return torch.sigmoid(x)
def _layernorm(x, axis=-1, eps=1e-5):
    m = x.mean(dim=axis, keepdim=True)
    v = x.var(dim=axis, keepdim=True, unbiased=False)
    return (x - m) / torch.sqrt(v + eps)
def _scatter_add(tgt, idx, src, axis=0):
    return tgt.clone().index_add_(axis, idx, src)
def _segment_sum(src, seg, n):
    out = torch.zeros((n,) + src.shape[1:], dtype=src.dtype)
    return out.index_add_(0, seg, src)
def _pad(x, pw):
    flat = tuple(v for pair in reversed(pw) for v in pair)
    return torch.nn.functional.pad(x, flat)

kernel_name = 'gated_mix__gqa_block_cached__glu_gated_swiglu__decode'

def setup_inputs():

    _w = (lambda a: (lambda t: t.to(torch.bfloat16) if t.is_floating_point() else t)(torch.as_tensor(a)))
    def _A_setup():
        B, Sq, D = 2, 1, 448
        Hq, Hkv, Sk, Dh = 16, 8, 32768, 256
        assert Hq % Hkv == 0, (Hq, Hkv)
        return {
            "x": _w((lambda *s: torch.randn(*s, dtype=torch.bfloat16) * 0.05)(B, Sq, D)),
            "k_cache": _w((lambda *s: torch.randn(*s, dtype=torch.bfloat16) * 3.2)(B, Hkv, Sk, Dh)),
            "v_cache": _w((lambda *s: torch.randn(*s, dtype=torch.bfloat16) * 0.05)(B, Hkv, Sk, Dh)),
            "wq": _w((lambda *s: torch.randn(*s, dtype=torch.bfloat16) * 3.2)(D, Hq * Dh) * (D ** -0.5)),
            "wo": _w((lambda *s: torch.randn(*s, dtype=torch.bfloat16) * 0.05)(Hq * Dh, D) * ((Hq * Dh) ** -0.5)),
        }
    _A_in = _A_setup()

    def _B_setup():
        B, S, D, F = 2, 1, 448, 1792
        return {
            "x": _w((lambda *s: torch.randn(*s, dtype=torch.bfloat16) * 0.05)(B, S, D)),
            "w1": _w((lambda *s: torch.randn(*s, dtype=torch.bfloat16) * 0.1)(D, F) * (2.0 / D) ** 0.5),
            "w3": _w((lambda *s: torch.randn(*s, dtype=torch.bfloat16) * 0.1)(D, F) * (2.0 / D) ** 0.5),
            "w2": _w((lambda *s: torch.randn(*s, dtype=torch.bfloat16) * 0.1)(F, D) * (2.0 / F) ** 0.5),
        }
    _B_in = _B_setup()

    return {
        "A_x": _A_in["x"],
        "A_k_cache": _A_in["k_cache"],
        "A_v_cache": _A_in["v_cache"],
        "A_wq": _A_in["wq"],
        "A_wo": _A_in["wo"],
        "B_x": _B_in["x"],
        "B_w1": _B_in["w1"],
        "B_w3": _B_in["w3"],
        "B_w2": _B_in["w2"],
        "gate_w": _w((lambda *s: torch.randn(*s, dtype=torch.bfloat16) * 0.05)(448) * 16.0),
    }

def reference(A_x, A_k_cache, A_v_cache, A_wq, A_wo, B_x, B_w1, B_w3, B_w2, gate_w):
    def _A_ref(x, k_cache, v_cache, wq, wo):
        B, Sq, D = x.shape
        Hq, Dh = 16, 256
        Hkv = k_cache.shape[1]
        rep = Hq // Hkv
        q = (lambda x, *d: x.permute(*d))((x @ wq).reshape(B, Sq, Hq, Dh), 0, 2, 1, 3)
        k = (lambda x, n, axis: torch.repeat_interleave(x, n, dim=axis))(k_cache, rep, axis=1)
        v = (lambda x, n, axis: torch.repeat_interleave(x, n, dim=axis))(v_cache, rep, axis=1)
        scores = torch.einsum("bhqd,bhkd->bhqk", q, k) * (Dh ** -0.5)
        p = _softmax(scores, axis=-1)
        o = torch.einsum("bhqk,bhkd->bhqd", p, v)
        return (lambda x, *d: x.permute(*d))(o, 0, 2, 1, 3).reshape(B, Sq, Hq * Dh) @ wo

    def _B_ref(x, w1, w3, w2):
        gate = torch.einsum("bsd,df->bsf", x, w1)
        up = torch.einsum("bsd,df->bsf", x, w3)
        h = _silu(gate) * up
        out = torch.einsum("bsf,fd->bsd", h, w2)
        return out

    x = A_x
    g = _sigmoid((x * gate_w).sum(-1, keepdims=True))
    a = _A_ref(x, A_k_cache, A_v_cache, A_wq, A_wo)
    b = _B_ref(x, B_w1, B_w3, B_w2)
    return g * a + (1 - g) * b
```

```asm
; @launch grid=(256,1,1) block=(384,1,1) lds=94208
.amdgcn_target "amdgcn-amd-amdhsa--gfx950"
.text
.globl gated_mix__gqa_block_cached__glu_gated_swiglu__decode_kernel
.p2align 8
.type gated_mix__gqa_block_cached__glu_gated_swiglu__decode_kernel,@function
gated_mix__gqa_block_cached__glu_gated_swiglu__decode_kernel:
    s_cmp_ge_u32 s2, 256
    s_cbranch_scc1 L_end
    s_load_dwordx16 s[4:19], s[0:1], 0
    s_load_dwordx8 s[20:27], s[0:1], 64
    s_load_dwordx2 s[28:29], s[0:1], 96
    v_lshrrev_b32 v1, 6, v0
    v_and_b32 v0, 63, v0
    v_readfirstlane_b32 s3, v1
    s_and_b32 s52, s2, 127
    s_lshr_b32 s53, s2, 7
    s_lshr_b32 s54, s52, 3
    s_and_b32 s55, s52, 7
    s_lshl_b32 s55, s55, 1
    s_add_u32 s55, s55, s53
    s_lshr_b32 s56, s54, 3
    s_and_b32 s57, s54, 7
    s_mov_b32 s62, 0xffff0000
    v_and_b32 v12, 15, v0
    v_lshrrev_b32 v13, 4, v0
    s_cmp_ge_u32 s3, 4
    s_cbranch_scc1 L_notstream
    v_lshrrev_b32 v14, 1, v12
    v_lshlrev_b32 v1, 9, v14
    v_and_b32 v15, 1, v12
    v_lshl_or_b32 v1, v15, 6, v1
    v_lshl_or_b32 v1, v13, 4, v1
    s_lshl_b32 s66, s53, 2
    s_add_u32 s66, s66, s3
    s_lshl_b32 s66, s66, 13
    s_lshl_b32 s67, s52, 21
    s_mov_b32 s60, s66
    s_mov_b32 s34, 0x200000
    s_mov_b32 s35, 0x00020000
    s_waitcnt lgkmcnt(0)
    s_add_u32 s32, s6, s67
    s_addc_u32 s33, s7, 0
    s_barrier
    s_add_u32 s61, s60, 4096
    buffer_load_dwordx4 v[128:131], v1, s[32:35], s60 offen offset:0 nt
    buffer_load_dwordx4 v[132:135], v1, s[32:35], s60 offen offset:128 nt
    buffer_load_dwordx4 v[136:139], v1, s[32:35], s60 offen offset:256 nt
    buffer_load_dwordx4 v[140:143], v1, s[32:35], s60 offen offset:384 nt
    buffer_load_dwordx4 v[144:147], v1, s[32:35], s61 offen offset:0 nt
    buffer_load_dwordx4 v[148:151], v1, s[32:35], s61 offen offset:128 nt
    s_branch L_stream
L_notstream:
    s_cmp_lg_u32 s3, 5
    s_cbranch_scc1 L_helper
    s_barrier
    s_branch L_gov
L_helper:
    s_setprio 3
    v_lshrrev_b32 v1, 3, v0
    v_lshlrev_b32 v1, 13, v1
    v_and_b32 v2, 7, v0
    v_lshl_or_b32 v1, v2, 4, v1
    s_lshr_b32 s66, s2, 2
    s_lshl_b32 s66, s66, 7
    s_and_b32 s79, s2, 3
    s_mul_i32 s67, s79, 917504
    s_add_u32 s66, s66, s67
    v_add_u32 v1, s66, v1
    v_lshlrev_b32 v2, 4, v0
    v_and_b32 v7, 1, v0
    s_waitcnt lgkmcnt(0)
    s_load_dword s58, s[28:29], 0
    s_mov_b32 s40, s10
    s_mov_b32 s41, s11
    s_mov_b32 s42, 0x380000
    s_mov_b32 s43, 0x00020000
    s_mov_b32 m0, 0x7000
    s_mov_b32 s71, 0x0
    buffer_load_dwordx4 v1, s[40:43], s71 offen nt lds
    s_mov_b32 m0, 0x7400
    s_mov_b32 s71, 0x10000
    buffer_load_dwordx4 v1, s[40:43], s71 offen nt lds
    s_mov_b32 m0, 0x7800
    s_mov_b32 s71, 0x20000
    buffer_load_dwordx4 v1, s[40:43], s71 offen nt lds
    s_mov_b32 m0, 0x7c00
    s_mov_b32 s71, 0x30000
    buffer_load_dwordx4 v1, s[40:43], s71 offen nt lds
    s_mov_b32 m0, 0x8000
    s_mov_b32 s71, 0x40000
    buffer_load_dwordx4 v1, s[40:43], s71 offen nt lds
    s_mov_b32 m0, 0x8400
    s_mov_b32 s71, 0x50000
    buffer_load_dwordx4 v1, s[40:43], s71 offen nt lds
    s_mov_b32 m0, 0x8800
    s_mov_b32 s71, 0x60000
    buffer_load_dwordx4 v1, s[40:43], s71 offen nt lds
    s_mov_b32 m0, 0x8c00
    s_mov_b32 s71, 0x70000
    buffer_load_dwordx4 v1, s[40:43], s71 offen nt lds
    s_mov_b32 m0, 0x9000
    s_mov_b32 s71, 0x80000
    buffer_load_dwordx4 v1, s[40:43], s71 offen nt lds
    s_mov_b32 m0, 0x9400
    s_mov_b32 s71, 0x90000
    buffer_load_dwordx4 v1, s[40:43], s71 offen nt lds
    s_mov_b32 m0, 0x9800
    s_mov_b32 s71, 0xa0000
    buffer_load_dwordx4 v1, s[40:43], s71 offen nt lds
    s_mov_b32 m0, 0x9c00
    s_mov_b32 s71, 0xb0000
    buffer_load_dwordx4 v1, s[40:43], s71 offen nt lds
    s_mov_b32 m0, 0xa000
    s_mov_b32 s71, 0xc0000
    buffer_load_dwordx4 v1, s[40:43], s71 offen nt lds
    s_mov_b32 m0, 0xa400
    s_mov_b32 s71, 0xd0000
    buffer_load_dwordx4 v1, s[40:43], s71 offen nt lds
    s_mov_b32 s40, s4
    s_mov_b32 s41, s5
    s_mov_b32 s42, 0x700
    s_mov_b32 s43, 0x00020000
    s_mov_b32 m0, 0x4800
    s_mov_b32 s71, 0x0
    buffer_load_dwordx4 v2, s[40:43], s71 offen  lds
    s_mov_b32 m0, 0x4c00
    s_mov_b32 s71, 0x400
    buffer_load_dwordx4 v2, s[40:43], s71 offen  lds
    s_barrier
    s_mov_b32 s36, s28
    s_mov_b32 s37, s29
    s_mov_b32 s38, 0x200000
    s_mov_b32 s39, 0x00020000
    s_mov_b32 s48, 0x7060501
    s_mov_b32 s49, 0x7060502
    s_mov_b32 s50, 0x7060503
    s_mov_b32 s46, 0x04000c0c
    s_mov_b32 s47, 0x0706000c
    v_lshrrev_b32 v5, 2, v12
    v_lshl_add_u32 v5, v13, 3, v5
    v_and_b32 v6, 3, v12
    v_lshlrev_b32 v3, 7, v5
    v_lshl_or_b32 v3, v6, 3, v3
    v_add_u32 v3, 0x7000, v3
    v_mul_u32_u24 v4, 896, v7
    v_lshl_add_u32 v4, v13, 4, v4
    v_add_u32 v4, 0x4800, v4
    v_subrev_u32 v11, 2048, v3
    s_mov_b32 s64, 0
    s_mov_b32 s65, -1
    v_cndmask_b32_e64 v11, v3, v11, s[64:65]
    s_mul_i32 s68, s79, 224
    v_add_u32 v20, s68, v4
    v_mov_b32 v21, 0x4f00
    s_mov_b32 s64, 0x30003
    s_mov_b32 s65, 0x30003
    v_cndmask_b32_e64 v240, v21, v20, s[64:65]
    s_mov_b32 s65, 0
    v_cndmask_b32_e64 v244, v21, v20, s[64:65]
    s_mov_b32 s64, 0xc000c
    s_mov_b32 s65, 0xc000c
    v_cndmask_b32_e64 v241, v21, v20, s[64:65]
    s_mov_b32 s65, 0
    v_cndmask_b32_e64 v245, v21, v20, s[64:65]
    s_mov_b32 s64, 0x300030
    s_mov_b32 s65, 0x300030
    v_cndmask_b32_e64 v242, v21, v20, s[64:65]
    s_mov_b32 s65, 0
    v_cndmask_b32_e64 v246, v21, v20, s[64:65]
    s_mov_b32 s64, 0xc000c0
    s_mov_b32 s65, 0xc000c0
    v_cndmask_b32_e64 v243, v21, v20, s[64:65]
    s_mov_b32 s65, 0
    v_cndmask_b32_e64 v247, v21, v20, s[64:65]
    v_lshlrev_b32 v8, 8, v7
    v_lshrrev_b32 v9, 1, v12
    v_lshl_add_u32 v8, v9, 6, v8
    v_lshl_add_u32 v8, v13, 4, v8
    s_lshl_b32 s67, s2, 9
    s_add_u32 s67, s67, 0x20000
    v_add_u32 v8, s67, v8
    s_lshl_b32 s67, s57, 14
    s_lshl_b32 s71, s56, 8
    s_add_u32 s67, s67, s71
    s_add_u32 s67, s67, 0x20000
    v_lshlrev_b32 v9, 11, v13
    v_lshl_add_u32 v9, v12, 4, v9
    v_add_u32 v9, s67, v9
    v_lshlrev_b32 v10, 3, v0
    v_add_u32 v10, 0x4000, v10
    s_lshl_b32 s67, s57, 4
    s_add_u32 s67, s67, s55
    s_waitcnt lgkmcnt(0)
    s_add_u32 s76, s58, 2
    s_or_b32 s76, s76, 1
    s_mul_i32 s58, s76, 0x9E3779B1
    s_waitcnt vmcnt(0)
    ds_read_b128 v[24:27], v240 offset:0
    ds_read_b64_tr_b16 v[144:145], v3 offset:0
    ds_read_b64_tr_b16 v[146:147], v3 offset:512
    ds_read_b128 v[28:31], v241 offset:0
    ds_read_b64_tr_b16 v[148:149], v3 offset:32
    ds_read_b64_tr_b16 v[150:151], v3 offset:544
    ds_read_b128 v[32:35], v242 offset:0
    ds_read_b64_tr_b16 v[152:153], v3 offset:64
    ds_read_b64_tr_b16 v[154:155], v3 offset:576
    ds_read_b128 v[36:39], v243 offset:0
    ds_read_b64_tr_b16 v[156:157], v3 offset:96
    ds_read_b64_tr_b16 v[158:159], v3 offset:608
    ds_read_b128 v[40:43], v240 offset:64
    ds_read_b64_tr_b16 v[160:161], v3 offset:4096
    ds_read_b64_tr_b16 v[162:163], v3 offset:4608
    s_waitcnt lgkmcnt(12)
    v_mfma_f32_16x16x32_bf16 v[128:131], v[144:147], v[24:27], 0
    ds_read_b128 v[44:47], v241 offset:64
    ds_read_b64_tr_b16 v[164:165], v3 offset:4128
    ds_read_b64_tr_b16 v[166:167], v3 offset:4640
    s_waitcnt lgkmcnt(12)
    v_mfma_f32_16x16x32_bf16 v[128:131], v[148:151], v[28:31], v[128:131]
    ds_read_b128 v[48:51], v242 offset:64
    ds_read_b64_tr_b16 v[168:169], v3 offset:4160
    ds_read_b64_tr_b16 v[170:171], v3 offset:4672
    s_waitcnt lgkmcnt(12)
    v_mfma_f32_16x16x32_bf16 v[128:131], v[152:155], v[32:35], v[128:131]
    ds_read_b128 v[52:55], v243 offset:64
    ds_read_b64_tr_b16 v[172:173], v3 offset:4192
    ds_read_b64_tr_b16 v[174:175], v3 offset:4704
    s_waitcnt lgkmcnt(12)
    v_mfma_f32_16x16x32_bf16 v[128:131], v[156:159], v[36:39], v[128:131]
    ds_read_b128 v[56:59], v240 offset:128
    ds_read_b64_tr_b16 v[176:177], v3 offset:8192
    ds_read_b64_tr_b16 v[178:179], v3 offset:8704
    s_waitcnt lgkmcnt(12)
    v_mfma_f32_16x16x32_bf16 v[128:131], v[160:163], v[40:43], v[128:131]
    ds_read_b128 v[60:63], v241 offset:128
    ds_read_b64_tr_b16 v[180:181], v3 offset:8224
    ds_read_b64_tr_b16 v[182:183], v3 offset:8736
    s_waitcnt lgkmcnt(12)
    v_mfma_f32_16x16x32_bf16 v[128:131], v[164:167], v[44:47], v[128:131]
    ds_read_b128 v[64:67], v242 offset:128
    ds_read_b64_tr_b16 v[184:185], v3 offset:8256
    ds_read_b64_tr_b16 v[186:187], v3 offset:8768
    s_waitcnt lgkmcnt(12)
    v_mfma_f32_16x16x32_bf16 v[128:131], v[168:171], v[48:51], v[128:131]
    ds_read_b128 v[68:71], v243 offset:128
    ds_read_b64_tr_b16 v[188:189], v3 offset:8288
    ds_read_b64_tr_b16 v[190:191], v3 offset:8800
    s_waitcnt lgkmcnt(12)
    v_mfma_f32_16x16x32_bf16 v[128:131], v[172:175], v[52:55], v[128:131]
    ds_read_b128 v[72:75], v244 offset:192
    ds_read_b64_tr_b16 v[192:193], v11 offset:12288
    ds_read_b64_tr_b16 v[194:195], v11 offset:12800
    s_waitcnt lgkmcnt(12)
    v_mfma_f32_16x16x32_bf16 v[128:131], v[176:179], v[56:59], v[128:131]
    ds_read_b128 v[76:79], v245 offset:192
    ds_read_b64_tr_b16 v[196:197], v11 offset:12320
    ds_read_b64_tr_b16 v[198:199], v11 offset:12832
    s_waitcnt lgkmcnt(12)
    v_mfma_f32_16x16x32_bf16 v[128:131], v[180:183], v[60:63], v[128:131]
    ds_read_b128 v[80:83], v246 offset:192
    ds_read_b64_tr_b16 v[200:201], v11 offset:12352
    ds_read_b64_tr_b16 v[202:203], v11 offset:12864
    s_waitcnt lgkmcnt(12)
    v_mfma_f32_16x16x32_bf16 v[128:131], v[184:187], v[64:67], v[128:131]
    ds_read_b128 v[84:87], v247 offset:192
    ds_read_b64_tr_b16 v[204:205], v11 offset:12384
    ds_read_b64_tr_b16 v[206:207], v11 offset:12896
    s_waitcnt lgkmcnt(12)
    v_mfma_f32_16x16x32_bf16 v[128:131], v[188:191], v[68:71], v[128:131]
    s_waitcnt lgkmcnt(9)
    v_mfma_f32_16x16x32_bf16 v[128:131], v[192:195], v[72:75], v[128:131]
    s_waitcnt lgkmcnt(6)
    v_mfma_f32_16x16x32_bf16 v[128:131], v[196:199], v[76:79], v[128:131]
    s_waitcnt lgkmcnt(3)
    v_mfma_f32_16x16x32_bf16 v[128:131], v[200:203], v[80:83], v[128:131]
    s_waitcnt lgkmcnt(0)
    v_mfma_f32_16x16x32_bf16 v[128:131], v[204:207], v[84:87], v[128:131]
    s_nop 7
    v_perm_b32 v132, v128, v131, s48
    v_perm_b32 v133, v129, v131, s49
    v_perm_b32 v134, v130, v131, s50
    v_bitop3_b32 v135, v132, v133, v134 bitop3:0x96
    v_xor_b32 v135, s58, v135
    s_mov_b32 s64, 0x00ff00ff
    s_mov_b32 s65, 0x00ff00ff
    s_mov_b64 exec, s[64:65]
    buffer_store_dwordx4 v[132:135], v8, s[36:39], 0 offen sc1
    s_mov_b64 exec, -1
    s_mov_b32 s40, s12
    s_mov_b32 s41, s13
    s_mov_b32 s42, 0x380000
    s_mov_b32 s43, 0x00020000
    s_mul_i32 s68, s67, 28672
    s_mov_b32 m0, 0x10000
    s_add_u32 s71, s68, 0x0
    buffer_load_dwordx4 v2, s[40:43], s71 offen nt lds
    s_waitcnt vmcnt(0)
    s_mov_b32 m0, 0x10400
    s_add_u32 s71, s68, 0x400
    buffer_load_dwordx4 v2, s[40:43], s71 offen nt lds
    s_waitcnt vmcnt(0)
    s_mov_b32 s66, 0x2000
    s_mov_b32 s70, 0x40000
L_poll51:
    buffer_load_dwordx4 v[160:163], v9, s[36:39], 0 offen offset:0 sc1
    buffer_load_dwordx4 v[164:167], v9, s[36:39], 0 offen offset:512 sc1
    buffer_load_dwordx4 v[168:171], v9, s[36:39], 0 offen offset:1024 sc1
    buffer_load_dwordx4 v[172:175], v9, s[36:39], 0 offen offset:1536 sc1
    buffer_load_dwordx4 v[176:179], v9, s[36:39], s66 offen offset:0 sc1
    buffer_load_dwordx4 v[180:183], v9, s[36:39], s66 offen offset:512 sc1
    buffer_load_dwordx4 v[184:187], v9, s[36:39], s66 offen offset:1024 sc1
    buffer_load_dwordx4 v[188:191], v9, s[36:39], s66 offen offset:1536 sc1
    s_waitcnt vmcnt(0)
    v_bitop3_b32 v144, v160, v161, v162 bitop3:0x96
    v_xor_b32 v144, v144, v163
    v_cmp_ne_u32_e64 s[72:73], s58, v144
    v_bitop3_b32 v145, v164, v165, v166 bitop3:0x96
    v_xor_b32 v145, v145, v167
    v_cmp_ne_u32_e64 s[74:75], s58, v145
    s_or_b64 s[72:73], s[72:73], s[74:75]
    v_bitop3_b32 v146, v168, v169, v170 bitop3:0x96
    v_xor_b32 v146, v146, v171
    v_cmp_ne_u32_e64 s[74:75], s58, v146
    s_or_b64 s[72:73], s[72:73], s[74:75]
    v_bitop3_b32 v147, v172, v173, v174 bitop3:0x96
    v_xor_b32 v147, v147, v175
    v_cmp_ne_u32_e64 s[74:75], s58, v147
    s_or_b64 s[72:73], s[72:73], s[74:75]
    v_bitop3_b32 v148, v176, v177, v178 bitop3:0x96
    v_xor_b32 v148, v148, v179
    v_cmp_ne_u32_e64 s[74:75], s58, v148
    s_or_b64 s[72:73], s[72:73], s[74:75]
    v_bitop3_b32 v149, v180, v181, v182 bitop3:0x96
    v_xor_b32 v149, v149, v183
    v_cmp_ne_u32_e64 s[74:75], s58, v149
    s_or_b64 s[72:73], s[72:73], s[74:75]
    v_bitop3_b32 v150, v184, v185, v186 bitop3:0x96
    v_xor_b32 v150, v150, v187
    v_cmp_ne_u32_e64 s[74:75], s58, v150
    s_or_b64 s[72:73], s[72:73], s[74:75]
    v_bitop3_b32 v151, v188, v189, v190 bitop3:0x96
    v_xor_b32 v151, v151, v191
    v_cmp_ne_u32_e64 s[74:75], s58, v151
    s_or_b64 s[72:73], s[72:73], s[74:75]
    s_cmp_eq_u64 s[72:73], 0
    s_cbranch_scc1 L_pdone52
    s_mov_b64 exec, s[72:73]
    s_sub_u32 s70, s70, 1
    s_cmp_lg_u32 s70, 0
    s_cbranch_scc1 L_poll51
L_pdone52:
    s_mov_b64 exec, -1
    v_perm_b32 v163, v162, v161, s46
    v_perm_b32 v167, v166, v165, s46
    v_perm_b32 v171, v170, v169, s46
    v_perm_b32 v175, v174, v173, s46
    v_perm_b32 v179, v178, v177, s46
    v_perm_b32 v183, v182, v181, s46
    v_perm_b32 v187, v186, v185, s46
    v_perm_b32 v191, v190, v189, s46
    v_perm_b32 v163, v163, v160, s47
    v_perm_b32 v167, v167, v164, s47
    v_perm_b32 v171, v171, v168, s47
    v_perm_b32 v175, v175, v172, s47
    v_perm_b32 v179, v179, v176, s47
    v_perm_b32 v183, v183, v180, s47
    v_perm_b32 v187, v187, v184, s47
    v_perm_b32 v191, v191, v188, s47
    v_add_f32 v160, v160, v164
    v_add_f32 v168, v168, v172
    v_add_f32 v161, v161, v165
    v_add_f32 v169, v169, v173
    v_add_f32 v162, v162, v166
    v_add_f32 v170, v170, v174
    v_add_f32 v163, v163, v167
    v_add_f32 v171, v171, v175
    v_add_f32 v160, v160, v168
    v_add_f32 v161, v161, v169
    v_add_f32 v162, v162, v170
    v_add_f32 v163, v163, v171
    v_cvt_pk_bf16_f32 v136, v160, v161
    v_cvt_pk_bf16_f32 v137, v162, v163
    v_add_f32 v176, v176, v180
    v_add_f32 v184, v184, v188
    v_add_f32 v177, v177, v181
    v_add_f32 v185, v185, v189
    v_add_f32 v178, v178, v182
    v_add_f32 v186, v186, v190
    v_add_f32 v179, v179, v183
    v_add_f32 v187, v187, v191
    v_add_f32 v176, v176, v184
    v_add_f32 v177, v177, v185
    v_add_f32 v178, v178, v186
    v_add_f32 v179, v179, v187
    v_cvt_pk_bf16_f32 v138, v176, v177
    v_cvt_pk_bf16_f32 v139, v178, v179
    ds_write_b64 v10, v[136:137]
    ds_write_b64 v10, v[138:139] offset:512
    v_mov_b32 v144, s58
    v_mov_b32 v145, 0x4400
    ds_write_b32 v145, v144
    s_waitcnt lgkmcnt(0)
    s_barrier
    s_and_b32 s68, s2, 7
    s_lshr_b32 s69, s2, 6
    s_lshl_b32 s69, s69, 3
    s_add_u32 s68, s68, s69
    s_cmp_ge_u32 s68, 28
    s_cbranch_scc1 L_noffn
    s_bfe_u32 s79, s2, 0x30003
    s_lshl_b32 s77, s68, 3
    s_add_u32 s77, s77, s79
    v_lshrrev_b32 v8, 3, v0
    v_mul_u32_u24 v1, 3584, v8
    v_and_b32 v8, 7, v0
    v_lshl_add_u32 v1, v8, 4, v1
    s_lshl_b32 s68, s68, 7
    s_mul_i32 s71, s79, 200704
    s_add_u32 s68, s68, s71
    v_add_u32 v1, s68, v1
    s_mov_b32 s40, s16
    s_mov_b32 s41, s17
    s_mov_b32 s42, 0x188000
    s_mov_b32 s43, 0x00020000
    s_mov_b32 s32, s18
    s_mov_b32 s33, s19
    s_mov_b32 s34, 0x188000
    s_mov_b32 s35, 0x00020000
    s_mov_b32 m0, 0xa800
    s_mov_b32 s71, 0x0
    buffer_load_dwordx4 v1, s[40:43], s71 offen nt lds
    s_mov_b32 m0, 0xc400
    s_mov_b32 s71, 0x0
    buffer_load_dwordx4 v1, s[32:35], s71 offen nt lds
    s_waitcnt vmcnt(2)
    s_mov_b32 m0, 0xac00
    s_mov_b32 s71, 0x7000
    buffer_load_dwordx4 v1, s[40:43], s71 offen nt lds
    s_mov_b32 m0, 0xc800
    s_mov_b32 s71, 0x7000
    buffer_load_dwordx4 v1, s[32:35], s71 offen nt lds
    s_waitcnt vmcnt(2)
    s_mov_b32 m0, 0xb000
    s_mov_b32 s71, 0xe000
    buffer_load_dwordx4 v1, s[40:43], s71 offen nt lds
    s_mov_b32 m0, 0xcc00
    s_mov_b32 s71, 0xe000
    buffer_load_dwordx4 v1, s[32:35], s71 offen nt lds
    s_waitcnt vmcnt(2)
    s_mov_b32 m0, 0xb400
    s_mov_b32 s71, 0x15000
    buffer_load_dwordx4 v1, s[40:43], s71 offen nt lds
    s_mov_b32 m0, 0xd000
    s_mov_b32 s71, 0x15000
    buffer_load_dwordx4 v1, s[32:35], s71 offen nt lds
    s_waitcnt vmcnt(2)
    s_mov_b32 m0, 0xb800
    s_mov_b32 s71, 0x1c000
    buffer_load_dwordx4 v1, s[40:43], s71 offen nt lds
    s_mov_b32 m0, 0xd400
    s_mov_b32 s71, 0x1c000
    buffer_load_dwordx4 v1, s[32:35], s71 offen nt lds
    s_waitcnt vmcnt(2)
    s_mov_b32 m0, 0xbc00
    s_mov_b32 s71, 0x23000
    buffer_load_dwordx4 v1, s[40:43], s71 offen nt lds
    s_mov_b32 m0, 0xd800
    s_mov_b32 s71, 0x23000
    buffer_load_dwordx4 v1, s[32:35], s71 offen nt lds
    s_waitcnt vmcnt(2)
    s_mov_b32 m0, 0xc000
    s_mov_b32 s71, 0x2a000
    buffer_load_dwordx4 v1, s[40:43], s71 offen nt lds
    s_mov_b32 m0, 0xdc00
    s_mov_b32 s71, 0x2a000
    buffer_load_dwordx4 v1, s[32:35], s71 offen nt lds
    s_waitcnt vmcnt(2)
    s_mul_i32 s68, s79, 112
    v_add_u32 v8, s68, v4
    v_add_u32 v9, 64, v8
    s_mov_b32 s64, 0
    s_mov_b32 s65, 0xffff0000
    v_mov_b32 v10, 0x4f00
    v_cndmask_b32_e64 v9, v9, v10, s[64:65]
    ds_read_b128 v[16:19], v8
    ds_read_b128 v[20:23], v9
    v_lshlrev_b32 v3, 7, v5
    v_lshl_add_u32 v3, v6, 3, v3
    v_add_u32 v3, 0xa800, v3
    v_add_u32 v11, 4096, v3
    v_add_u32 v10, 3072, v3
    v_cndmask_b32_e64 v11, v11, v10, s[64:65]
    s_waitcnt lgkmcnt(0)
    s_mov_b32 s64, 0x30003
    s_mov_b32 s65, 0x30003
    v_cndmask_b32_e64 v24, 0, v16, s[64:65]
    v_cndmask_b32_e64 v25, 0, v17, s[64:65]
    v_cndmask_b32_e64 v26, 0, v18, s[64:65]
    v_cndmask_b32_e64 v27, 0, v19, s[64:65]
    v_cndmask_b32_e64 v28, 0, v20, s[64:65]
    v_cndmask_b32_e64 v29, 0, v21, s[64:65]
    v_cndmask_b32_e64 v30, 0, v22, s[64:65]
    v_cndmask_b32_e64 v31, 0, v23, s[64:65]
    s_mov_b32 s64, 0xc000c
    s_mov_b32 s65, 0xc000c
    v_cndmask_b32_e64 v32, 0, v16, s[64:65]
    v_cndmask_b32_e64 v33, 0, v17, s[64:65]
    v_cndmask_b32_e64 v34, 0, v18, s[64:65]
    v_cndmask_b32_e64 v35, 0, v19, s[64:65]
    v_cndmask_b32_e64 v36, 0, v20, s[64:65]
    v_cndmask_b32_e64 v37, 0, v21, s[64:65]
    v_cndmask_b32_e64 v38, 0, v22, s[64:65]
    v_cndmask_b32_e64 v39, 0, v23, s[64:65]
    s_mov_b32 s64, 0x300030
    s_mov_b32 s65, 0x300030
    v_cndmask_b32_e64 v40, 0, v16, s[64:65]
    v_cndmask_b32_e64 v41, 0, v17, s[64:65]
    v_cndmask_b32_e64 v42, 0, v18, s[64:65]
    v_cndmask_b32_e64 v43, 0, v19, s[64:65]
    v_cndmask_b32_e64 v44, 0, v20, s[64:65]
    v_cndmask_b32_e64 v45, 0, v21, s[64:65]
    v_cndmask_b32_e64 v46, 0, v22, s[64:65]
    v_cndmask_b32_e64 v47, 0, v23, s[64:65]
    s_mov_b32 s64, 0xc000c0
    s_mov_b32 s65, 0xc000c0
    v_cndmask_b32_e64 v48, 0, v16, s[64:65]
    v_cndmask_b32_e64 v49, 0, v17, s[64:65]
    v_cndmask_b32_e64 v50, 0, v18, s[64:65]
    v_cndmask_b32_e64 v51, 0, v19, s[64:65]
    v_cndmask_b32_e64 v52, 0, v20, s[64:65]
    v_cndmask_b32_e64 v53, 0, v21, s[64:65]
    v_cndmask_b32_e64 v54, 0, v22, s[64:65]
    v_cndmask_b32_e64 v55, 0, v23, s[64:65]
    s_mov_b32 s64, 0x3000300
    s_mov_b32 s65, 0x3000300
    v_cndmask_b32_e64 v56, 0, v16, s[64:65]
    v_cndmask_b32_e64 v57, 0, v17, s[64:65]
    v_cndmask_b32_e64 v58, 0, v18, s[64:65]
    v_cndmask_b32_e64 v59, 0, v19, s[64:65]
    v_cndmask_b32_e64 v60, 0, v20, s[64:65]
    v_cndmask_b32_e64 v61, 0, v21, s[64:65]
    v_cndmask_b32_e64 v62, 0, v22, s[64:65]
    v_cndmask_b32_e64 v63, 0, v23, s[64:65]
    s_mov_b32 s64, 0xc000c00
    s_mov_b32 s65, 0xc000c00
    v_cndmask_b32_e64 v64, 0, v16, s[64:65]
    v_cndmask_b32_e64 v65, 0, v17, s[64:65]
    v_cndmask_b32_e64 v66, 0, v18, s[64:65]
    v_cndmask_b32_e64 v67, 0, v19, s[64:65]
    v_cndmask_b32_e64 v68, 0, v20, s[64:65]
    v_cndmask_b32_e64 v69, 0, v21, s[64:65]
    v_cndmask_b32_e64 v70, 0, v22, s[64:65]
    v_cndmask_b32_e64 v71, 0, v23, s[64:65]
    s_mov_b32 s64, 0x30003000
    s_mov_b32 s65, 0x30003000
    v_cndmask_b32_e64 v72, 0, v16, s[64:65]
    v_cndmask_b32_e64 v73, 0, v17, s[64:65]
    v_cndmask_b32_e64 v74, 0, v18, s[64:65]
    v_cndmask_b32_e64 v75, 0, v19, s[64:65]
    v_cndmask_b32_e64 v76, 0, v20, s[64:65]
    v_cndmask_b32_e64 v77, 0, v21, s[64:65]
    v_cndmask_b32_e64 v78, 0, v22, s[64:65]
    v_cndmask_b32_e64 v79, 0, v23, s[64:65]
    s_mov_b32 s64, 0xc000c000
    s_mov_b32 s65, 0xc000c000
    v_cndmask_b32_e64 v80, 0, v16, s[64:65]
    v_cndmask_b32_e64 v81, 0, v17, s[64:65]
    v_cndmask_b32_e64 v82, 0, v18, s[64:65]
    v_cndmask_b32_e64 v83, 0, v19, s[64:65]
    v_cndmask_b32_e64 v84, 0, v20, s[64:65]
    v_cndmask_b32_e64 v85, 0, v21, s[64:65]
    v_cndmask_b32_e64 v86, 0, v22, s[64:65]
    v_cndmask_b32_e64 v87, 0, v23, s[64:65]
    s_waitcnt vmcnt(0)
    ds_read_b64_tr_b16 v[144:145], v3 offset:0
    ds_read_b64_tr_b16 v[146:147], v3 offset:512
    ds_read_b64_tr_b16 v[148:149], v11 offset:0
    ds_read_b64_tr_b16 v[150:151], v11 offset:512
    ds_read_b64_tr_b16 v[152:153], v3 offset:32
    ds_read_b64_tr_b16 v[154:155], v3 offset:544
    ds_read_b64_tr_b16 v[156:157], v11 offset:32
    ds_read_b64_tr_b16 v[158:159], v11 offset:544
    ds_read_b64_tr_b16 v[160:161], v3 offset:64
    ds_read_b64_tr_b16 v[162:163], v3 offset:576
    ds_read_b64_tr_b16 v[164:165], v11 offset:64
    ds_read_b64_tr_b16 v[166:167], v11 offset:576
    ds_read_b64_tr_b16 v[168:169], v3 offset:96
    ds_read_b64_tr_b16 v[170:171], v3 offset:608
    ds_read_b64_tr_b16 v[172:173], v11 offset:96
    s_waitcnt lgkmcnt(0)
    ds_read_b64_tr_b16 v[174:175], v11 offset:608
    s_waitcnt lgkmcnt(0)
    v_mfma_f32_16x16x32_bf16 v[128:131], v[144:147], v[24:27], 0
    v_mfma_f32_16x16x32_bf16 v[128:131], v[148:151], v[28:31], v[128:131]
    v_mfma_f32_16x16x32_bf16 v[128:131], v[152:155], v[32:35], v[128:131]
    v_mfma_f32_16x16x32_bf16 v[128:131], v[156:159], v[36:39], v[128:131]
    v_mfma_f32_16x16x32_bf16 v[128:131], v[160:163], v[40:43], v[128:131]
    v_mfma_f32_16x16x32_bf16 v[128:131], v[164:167], v[44:47], v[128:131]
    v_mfma_f32_16x16x32_bf16 v[128:131], v[168:171], v[48:51], v[128:131]
    v_mfma_f32_16x16x32_bf16 v[128:131], v[172:175], v[52:55], v[128:131]
    s_nop 7
    ds_read_b64_tr_b16 v[144:145], v3 offset:7168
    ds_read_b64_tr_b16 v[146:147], v3 offset:7680
    ds_read_b64_tr_b16 v[148:149], v11 offset:7168
    ds_read_b64_tr_b16 v[150:151], v11 offset:7680
    ds_read_b64_tr_b16 v[152:153], v3 offset:7200
    ds_read_b64_tr_b16 v[154:155], v3 offset:7712
    ds_read_b64_tr_b16 v[156:157], v11 offset:7200
    ds_read_b64_tr_b16 v[158:159], v11 offset:7712
    ds_read_b64_tr_b16 v[160:161], v3 offset:7232
    ds_read_b64_tr_b16 v[162:163], v3 offset:7744
    ds_read_b64_tr_b16 v[164:165], v11 offset:7232
    ds_read_b64_tr_b16 v[166:167], v11 offset:7744
    ds_read_b64_tr_b16 v[168:169], v3 offset:7264
    ds_read_b64_tr_b16 v[170:171], v3 offset:7776
    ds_read_b64_tr_b16 v[172:173], v11 offset:7264
    s_waitcnt lgkmcnt(0)
    ds_read_b64_tr_b16 v[174:175], v11 offset:7776
    s_waitcnt lgkmcnt(0)
    v_mfma_f32_16x16x32_bf16 v[128:131], v[144:147], v[56:59], v[128:131]
    v_mfma_f32_16x16x32_bf16 v[128:131], v[148:151], v[60:63], v[128:131]
    v_mfma_f32_16x16x32_bf16 v[128:131], v[152:155], v[64:67], v[128:131]
    v_mfma_f32_16x16x32_bf16 v[128:131], v[156:159], v[68:71], v[128:131]
    v_mfma_f32_16x16x32_bf16 v[128:131], v[160:163], v[72:75], v[128:131]
    v_mfma_f32_16x16x32_bf16 v[128:131], v[164:167], v[76:79], v[128:131]
    v_mfma_f32_16x16x32_bf16 v[128:131], v[168:171], v[80:83], v[128:131]
    v_mfma_f32_16x16x32_bf16 v[128:131], v[172:175], v[84:87], v[128:131]
    s_nop 7
    v_and_b32 v8, 7, v12
    v_lshlrev_b32 v8, 7, v8
    v_lshrrev_b32 v9, 3, v12
    v_lshl_add_u32 v8, v9, 6, v8
    v_lshl_add_u32 v8, v13, 4, v8
    s_lshl_b32 s68, s77, 10
    s_add_u32 s68, s68, 0x40000
    v_add_u32 v8, s68, v8
    v_perm_b32 v140, v128, v131, s48
    v_perm_b32 v141, v129, v131, s49
    v_perm_b32 v142, v130, v131, s50
    v_bitop3_b32 v143, v140, v141, v142 bitop3:0x96
    v_xor_b32 v143, s58, v143
    buffer_store_dwordx4 v[140:143], v8, s[36:39], 0 offen sc1
L_noffn:
    s_mov_b32 s40, s22
    s_mov_b32 s41, s23
    s_mov_b32 s42, 0x380
    s_mov_b32 s43, 0x00020000
    buffer_load_dwordx4 v[128:131], v2, s[40:43], 0 offen
    s_mul_i32 s68, s56, 896
    s_add_u32 s68, s68, 0x4800
    v_add_u32 v8, s68, v2
    ds_read_b128 v[132:135], v8
    v_mov_b32 v148, 0
    v_mov_b32 v149, 0
    v_mov_b32 v150, 0
    v_mov_b32 v151, 0
    v_add_u32 v9, 0xe800, v2
    ds_write_b128 v9, v[148:151]
    ds_write_b128 v9, v[148:151] offset:1024
    s_waitcnt vmcnt(0) lgkmcnt(0)
    v_lshlrev_b32 v136, 16, v128
    v_and_b32 v137, s62, v128
    v_lshlrev_b32 v138, 16, v132
    v_and_b32 v139, s62, v132
    v_mul_f32 v136, v136, v138
    v_mul_f32 v137, v137, v139
    v_cvt_pk_bf16_f32 v137, v136, v137
    v_lshlrev_b32 v136, 16, v137
    v_and_b32 v137, s62, v137
    v_add_f32 v140, v136, v137
    v_lshlrev_b32 v136, 16, v129
    v_and_b32 v137, s62, v129
    v_lshlrev_b32 v138, 16, v133
    v_and_b32 v139, s62, v133
    v_mul_f32 v136, v136, v138
    v_mul_f32 v137, v137, v139
    v_cvt_pk_bf16_f32 v137, v136, v137
    v_lshlrev_b32 v136, 16, v137
    v_and_b32 v137, s62, v137
    v_add_f32 v140, v140, v136
    v_add_f32 v140, v140, v137
    v_lshlrev_b32 v136, 16, v130
    v_and_b32 v137, s62, v130
    v_lshlrev_b32 v138, 16, v134
    v_and_b32 v139, s62, v134
    v_mul_f32 v136, v136, v138
    v_mul_f32 v137, v137, v139
    v_cvt_pk_bf16_f32 v137, v136, v137
    v_lshlrev_b32 v136, 16, v137
    v_and_b32 v137, s62, v137
    v_add_f32 v140, v140, v136
    v_add_f32 v140, v140, v137
    v_lshlrev_b32 v136, 16, v131
    v_and_b32 v137, s62, v131
    v_lshlrev_b32 v138, 16, v135
    v_and_b32 v139, s62, v135
    v_mul_f32 v136, v136, v138
    v_mul_f32 v137, v137, v139
    v_cvt_pk_bf16_f32 v137, v136, v137
    v_lshlrev_b32 v136, 16, v137
    v_and_b32 v137, s62, v137
    v_add_f32 v140, v140, v136
    v_add_f32 v140, v140, v137
    s_mov_b32 s64, -1
    s_mov_b32 s65, 0x00ffffff
    v_cndmask_b32_e64 v140, 0, v140, s[64:65]
    s_nop 1
    v_add_f32_dpp v140, v140, v140 row_ror:8 row_mask:0xf bank_mask:0xf
    s_nop 1
    v_add_f32_dpp v140, v140, v140 row_ror:4 row_mask:0xf bank_mask:0xf
    s_nop 1
    v_add_f32_dpp v140, v140, v140 row_ror:2 row_mask:0xf bank_mask:0xf
    s_nop 1
    v_add_f32_dpp v140, v140, v140 row_ror:1 row_mask:0xf bank_mask:0xf
    v_mov_b32 v141, v140
    s_nop 1
    v_permlane16_swap_b32 v140, v141
    s_nop 0
    v_add_f32 v140, v140, v141
    v_mov_b32 v141, v140
    s_nop 1
    v_permlane32_swap_b32 v140, v141
    s_nop 0
    v_add_f32 v140, v140, v141
    v_cvt_pk_bf16_f32 v140, v140, v140
    v_and_b32 v140, s62, v140
    v_mul_f32 v140, 0xbfb8aa3b, v140
    v_exp_f32 v140, v140
    s_nop 0
    v_add_f32 v140, 1.0, v140
    v_rcp_f32 v14, v140
    s_nop 0
    v_cvt_pk_bf16_f32 v14, v14, v14
    v_and_b32 v14, s62, v14
    v_sub_f32 v15, 1.0, v14
    v_cvt_pk_bf16_f32 v15, v15, v15
    v_and_b32 v15, s62, v15
    v_mov_b32 v8, 0x4404
    ds_write_b32 v8, v14
    v_lshlrev_b32 v8, 2, v6
    v_add_u32 v8, 0x4460, v8
    s_mov_b32 s70, 0x40000
L_w2l:
    s_sleep 16
    ds_read_b32 v9, v8
    s_waitcnt lgkmcnt(0)
    v_cmp_gt_u32 vcc, 992, v9
    s_sub_u32 s70, s70, 1
    s_cmp_eq_u32 s70, 0
    s_cbranch_scc1 L_w2d
    s_cmp_lg_u64 vcc, 0
    s_cbranch_scc1 L_w2l
L_w2d:
    v_lshlrev_b32 v8, 3, v7
    v_add_u32 v8, 0x4480, v8
    ds_read_b64 v[232:233], v8 offset:0
    ds_read_b64 v[234:235], v8 offset:16
    ds_read_b64 v[236:237], v8 offset:32
    ds_read_b64 v[238:239], v8 offset:48
    s_lshl_b32 s68, s54, 11
    s_add_u32 s68, s68, 0x10000
    s_lshl_b32 s69, s55, 7
    s_add_u32 s69, s69, s68
    v_add_u32 v9, s69, v2
    v_bfe_u32 v11, v0, 1, 4
    v_lshlrev_b32 v11, 7, v11
    v_lshl_add_u32 v11, v7, 4, v11
    v_add_u32 v11, s68, v11
    s_waitcnt lgkmcnt(0)
    v_max3_f32 v240, v232, v234, v236
    v_max_f32 v240, v240, v238
    v_sub_f32 v140, v232, v240
    v_sub_f32 v141, v234, v240
    v_sub_f32 v142, v236, v240
    v_sub_f32 v143, v238, v240
    v_exp_f32 v140, v140
    v_exp_f32 v141, v141
    v_exp_f32 v142, v142
    v_exp_f32 v143, v143
    s_nop 0
    v_mul_f32 v241, v140, v233
    v_fmac_f32 v241, v141, v235
    v_fmac_f32 v241, v142, v237
    v_fmac_f32 v241, v143, v239
    v_bitop3_b32 v242, v240, v241, s58 bitop3:0x96
    v_mov_b32 v243, v242
    s_mov_b64 exec, 0xff
    buffer_store_dwordx4 v[240:243], v9, s[36:39], 0 offen sc1
    s_mov_b64 exec, -1
    v_mov_b32 v200, 0
    v_mov_b32 v204, 0
    v_mov_b32 v208, 0
    v_mov_b32 v212, 0
    v_mov_b32 v216, 0
    v_mov_b32 v220, 0
    v_mov_b32 v224, 0
    s_cmp_ge_u32 s67, 112
    s_cbranch_scc1 L_noffn2
    s_mov_b32 s40, s20
    s_mov_b32 s41, s21
    s_mov_b32 s42, 0x188000
    s_mov_b32 s43, 0x00020000
    s_mul_i32 s68, s67, 14336
    s_mov_b32 m0, 0x7000
    s_add_u32 s71, s68, 0x0
    buffer_load_dwordx4 v2, s[40:43], s71 offen nt lds
    s_waitcnt vmcnt(0)
    s_mov_b32 m0, 0x7400
    s_add_u32 s71, s68, 0x400
    buffer_load_dwordx4 v2, s[40:43], s71 offen nt lds
    s_waitcnt vmcnt(0)
    s_mov_b32 m0, 0x7800
    s_add_u32 s71, s68, 0x800
    buffer_load_dwordx4 v2, s[40:43], s71 offen nt lds
    s_waitcnt vmcnt(0)
    s_mov_b32 m0, 0x7c00
    s_add_u32 s71, s68, 0xc00
    buffer_load_dwordx4 v2, s[40:43], s71 offen nt lds
    s_waitcnt vmcnt(0)
    s_mov_b32 m0, 0x8000
    s_add_u32 s71, s68, 0x1000
    buffer_load_dwordx4 v2, s[40:43], s71 offen nt lds
    s_waitcnt vmcnt(0)
    s_mov_b32 m0, 0x8400
    s_add_u32 s71, s68, 0x1400
    buffer_load_dwordx4 v2, s[40:43], s71 offen nt lds
    s_waitcnt vmcnt(0)
    s_mov_b32 m0, 0x8800
    s_add_u32 s71, s68, 0x1800
    buffer_load_dwordx4 v2, s[40:43], s71 offen nt lds
    s_waitcnt vmcnt(0)
    s_mov_b32 m0, 0x8c00
    s_add_u32 s71, s68, 0x1c00
    buffer_load_dwordx4 v2, s[40:43], s71 offen nt lds
    s_waitcnt vmcnt(0)
    s_mov_b32 m0, 0x9000
    s_add_u32 s71, s68, 0x2000
    buffer_load_dwordx4 v2, s[40:43], s71 offen nt lds
    s_waitcnt vmcnt(0)
    s_mov_b32 m0, 0x9400
    s_add_u32 s71, s68, 0x2400
    buffer_load_dwordx4 v2, s[40:43], s71 offen nt lds
    s_waitcnt vmcnt(0)
    s_mov_b32 m0, 0x9800
    s_add_u32 s71, s68, 0x2800
    buffer_load_dwordx4 v2, s[40:43], s71 offen nt lds
    s_waitcnt vmcnt(0)
    s_mov_b32 m0, 0x9c00
    s_add_u32 s71, s68, 0x2c00
    buffer_load_dwordx4 v2, s[40:43], s71 offen nt lds
    s_waitcnt vmcnt(0)
    s_mov_b32 m0, 0xa000
    s_add_u32 s71, s68, 0x3000
    buffer_load_dwordx4 v2, s[40:43], s71 offen nt lds
    s_waitcnt vmcnt(0)
    s_mov_b32 m0, 0xa400
    s_add_u32 s71, s68, 0x3400
    buffer_load_dwordx4 v2, s[40:43], s71 offen nt lds
    s_waitcnt vmcnt(0)
    v_lshrrev_b32 v9, 1, v12
    v_lshlrev_b32 v9, 10, v9
    v_lshl_add_u32 v9, v7, 6, v9
    v_lshl_add_u32 v9, v13, 4, v9
    s_lshr_b32 s68, s67, 2
    s_lshl_b32 s68, s68, 13
    s_and_b32 s69, s67, 3
    s_lshl_b32 s69, s69, 8
    s_add_u32 s68, s68, s69
    s_lshl_b32 s69, s56, 7
    s_add_u32 s68, s68, s69
    s_add_u32 s68, s68, 0x40000
    v_add_u32 v9, s68, v9
    s_mov_b32 s70, 0x40000
L_poll53:
    buffer_load_dwordx4 v[136:139], v9, s[36:39], 0 offen sc1
    s_waitcnt vmcnt(0)
    v_bitop3_b32 v144, v136, v137, v138 bitop3:0x96
    v_xor_b32 v144, v144, v139
    v_cmp_ne_u32_e64 s[72:73], s58, v144
    s_cmp_eq_u64 s[72:73], 0
    s_cbranch_scc1 L_pdone54
    s_mov_b64 exec, s[72:73]
    s_sleep 16
    s_sub_u32 s70, s70, 1
    s_cmp_lg_u32 s70, 0
    s_cbranch_scc1 L_poll53
L_pdone54:
    s_mov_b64 exec, -1
    v_perm_b32 v139, v138, v137, s46
    v_perm_b32 v139, v139, v136, s47
    s_nop 1
    v_add_f32_dpp v136, v136, v136 row_ror:8 row_mask:0xf bank_mask:0xf
    v_add_f32_dpp v137, v137, v137 row_ror:8 row_mask:0xf bank_mask:0xf
    v_add_f32_dpp v138, v138, v138 row_ror:8 row_mask:0xf bank_mask:0xf
    v_add_f32_dpp v139, v139, v139 row_ror:8 row_mask:0xf bank_mask:0xf
    v_add_f32_dpp v136, v136, v136 row_ror:4 row_mask:0xf bank_mask:0xf
    v_add_f32_dpp v137, v137, v137 row_ror:4 row_mask:0xf bank_mask:0xf
    v_add_f32_dpp v138, v138, v138 row_ror:4 row_mask:0xf bank_mask:0xf
    v_add_f32_dpp v139, v139, v139 row_ror:4 row_mask:0xf bank_mask:0xf
    v_add_f32_dpp v136, v136, v136 row_ror:2 row_mask:0xf bank_mask:0xf
    v_add_f32_dpp v137, v137, v137 row_ror:2 row_mask:0xf bank_mask:0xf
    v_add_f32_dpp v138, v138, v138 row_ror:2 row_mask:0xf bank_mask:0xf
    v_add_f32_dpp v139, v139, v139 row_ror:2 row_mask:0xf bank_mask:0xf
    v_lshrrev_b32 v8, 2, v0
    v_mul_u32_u24 v3, 896, v8
    v_lshl_add_u32 v3, v6, 3, v3
    v_add_u32 v3, 0x7000, v3
    ds_read_b64_tr_b16 v[144:145], v3 offset:0
    ds_read_b64_tr_b16 v[146:147], v3 offset:32
    ds_read_b64_tr_b16 v[148:149], v3 offset:64
    ds_read_b64_tr_b16 v[150:151], v3 offset:96
    ds_read_b64_tr_b16 v[152:153], v3 offset:128
    ds_read_b64_tr_b16 v[154:155], v3 offset:160
    ds_read_b64_tr_b16 v[156:157], v3 offset:192
    ds_read_b64_tr_b16 v[158:159], v3 offset:224
    ds_read_b64_tr_b16 v[160:161], v3 offset:256
    ds_read_b64_tr_b16 v[162:163], v3 offset:288
    ds_read_b64_tr_b16 v[164:165], v3 offset:320
    ds_read_b64_tr_b16 v[166:167], v3 offset:352
    ds_read_b64_tr_b16 v[168:169], v3 offset:384
    ds_read_b64_tr_b16 v[170:171], v3 offset:416
    s_waitcnt lgkmcnt(0)
    ds_read_b64_tr_b16 v[172:173], v3 offset:448
    ds_read_b64_tr_b16 v[174:175], v3 offset:480
    ds_read_b64_tr_b16 v[176:177], v3 offset:512
    ds_read_b64_tr_b16 v[178:179], v3 offset:544
    ds_read_b64_tr_b16 v[180:181], v3 offset:576
    ds_read_b64_tr_b16 v[182:183], v3 offset:608
    ds_read_b64_tr_b16 v[184:185], v3 offset:640
    ds_read_b64_tr_b16 v[186:187], v3 offset:672
    ds_read_b64_tr_b16 v[188:189], v3 offset:704
    ds_read_b64_tr_b16 v[190:191], v3 offset:736
    ds_read_b64_tr_b16 v[192:193], v3 offset:768
    ds_read_b64_tr_b16 v[194:195], v3 offset:800
    ds_read_b64_tr_b16 v[196:197], v3 offset:832
    ds_read_b64_tr_b16 v[198:199], v3 offset:864
    s_waitcnt lgkmcnt(0)
    v_cvt_pk_bf16_f32 v136, v136, v136
    v_and_b32 v136, s62, v136
    v_cvt_pk_bf16_f32 v137, v137, v137
    v_and_b32 v137, s62, v137
    v_cvt_pk_bf16_f32 v138, v138, v138
    v_and_b32 v138, s62, v138
    v_cvt_pk_bf16_f32 v139, v139, v139
    v_and_b32 v139, s62, v139
    s_nop 1
    v_mov_b32_dpp v128, v136 quad_perm:[0,0,2,2] row_mask:0xf bank_mask:0xf
    v_mov_b32_dpp v132, v136 quad_perm:[1,1,3,3] row_mask:0xf bank_mask:0xf
    v_mov_b32_dpp v129, v137 quad_perm:[0,0,2,2] row_mask:0xf bank_mask:0xf
    v_mov_b32_dpp v133, v137 quad_perm:[1,1,3,3] row_mask:0xf bank_mask:0xf
    v_mov_b32_dpp v130, v138 quad_perm:[0,0,2,2] row_mask:0xf bank_mask:0xf
    v_mov_b32_dpp v134, v138 quad_perm:[1,1,3,3] row_mask:0xf bank_mask:0xf
    v_mov_b32_dpp v131, v139 quad_perm:[0,0,2,2] row_mask:0xf bank_mask:0xf
    v_mov_b32_dpp v135, v139 quad_perm:[1,1,3,3] row_mask:0xf bank_mask:0xf
    v_mul_f32 v136, 0xbfb8aa3b, v128
    v_mul_f32 v137, 0xbfb8aa3b, v129
    v_mul_f32 v138, 0xbfb8aa3b, v130
    v_mul_f32 v139, 0xbfb8aa3b, v131
    v_exp_f32 v136, v136
    v_exp_f32 v137, v137
    v_exp_f32 v138, v138
    v_exp_f32 v139, v139
    s_nop 0
    v_add_f32 v136, 1.0, v136
    v_add_f32 v137, 1.0, v137
    v_add_f32 v138, 1.0, v138
    v_add_f32 v139, 1.0, v139
    v_rcp_f32 v136, v136
    v_rcp_f32 v137, v137
    v_rcp_f32 v138, v138
    v_rcp_f32 v139, v139
    s_nop 0
    v_mul_f32 v128, v128, v136
    v_mul_f32 v129, v129, v137
    v_mul_f32 v130, v130, v138
    v_mul_f32 v131, v131, v139
    v_cvt_pk_bf16_f32 v128, v128, v128
    v_and_b32 v128, s62, v128
    v_cvt_pk_bf16_f32 v129, v129, v129
    v_and_b32 v129, s62, v129
    v_cvt_pk_bf16_f32 v130, v130, v130
    v_and_b32 v130, s62, v130
    v_cvt_pk_bf16_f32 v131, v131, v131
    v_and_b32 v131, s62, v131
    v_mul_f32 v128, v128, v132
    v_mul_f32 v129, v129, v133
    v_mul_f32 v130, v130, v134
    v_mul_f32 v131, v131, v135
    v_cvt_pk_bf16_f32 v128, v128, v129
    v_cvt_pk_bf16_f32 v129, v130, v131
    s_mov_b32 s64, 0xf000f
    s_mov_b32 s65, 0xf000f
    v_cndmask_b32_e64 v132, 0, v128, s[64:65]
    v_cndmask_b32_e64 v133, 0, v129, s[64:65]
    s_mov_b32 s64, 0xf000f0
    s_mov_b32 s65, 0xf000f0
    v_cndmask_b32_e64 v134, 0, v128, s[64:65]
    v_cndmask_b32_e64 v135, 0, v129, s[64:65]
    s_mov_b32 s64, 0xf000f00
    s_mov_b32 s65, 0xf000f00
    v_cndmask_b32_e64 v136, 0, v128, s[64:65]
    v_cndmask_b32_e64 v137, 0, v129, s[64:65]
    s_mov_b32 s64, 0xf000f000
    s_mov_b32 s65, 0xf000f000
    v_cndmask_b32_e64 v138, 0, v128, s[64:65]
    v_cndmask_b32_e64 v139, 0, v129, s[64:65]
    s_nop 1
    v_mfma_f32_16x16x16_bf16 v[200:203], v[132:133], v[144:145], 0
    v_mfma_f32_16x16x16_bf16 v[204:207], v[132:133], v[146:147], 0
    v_mfma_f32_16x16x16_bf16 v[208:211], v[132:133], v[148:149], 0
    v_mfma_f32_16x16x16_bf16 v[212:215], v[132:133], v[150:151], 0
    v_mfma_f32_16x16x16_bf16 v[216:219], v[132:133], v[152:153], 0
    v_mfma_f32_16x16x16_bf16 v[220:223], v[132:133], v[154:155], 0
    v_mfma_f32_16x16x16_bf16 v[224:227], v[132:133], v[156:157], 0
    v_mfma_f32_16x16x16_bf16 v[200:203], v[134:135], v[158:159], v[200:203]
    v_mfma_f32_16x16x16_bf16 v[204:207], v[134:135], v[160:161], v[204:207]
    v_mfma_f32_16x16x16_bf16 v[208:211], v[134:135], v[162:163], v[208:211]
    v_mfma_f32_16x16x16_bf16 v[212:215], v[134:135], v[164:165], v[212:215]
    v_mfma_f32_16x16x16_bf16 v[216:219], v[134:135], v[166:167], v[216:219]
    v_mfma_f32_16x16x16_bf16 v[220:223], v[134:135], v[168:169], v[220:223]
    v_mfma_f32_16x16x16_bf16 v[224:227], v[134:135], v[170:171], v[224:227]
    v_mfma_f32_16x16x16_bf16 v[200:203], v[136:137], v[172:173], v[200:203]
    v_mfma_f32_16x16x16_bf16 v[204:207], v[136:137], v[174:175], v[204:207]
    v_mfma_f32_16x16x16_bf16 v[208:211], v[136:137], v[176:177], v[208:211]
    v_mfma_f32_16x16x16_bf16 v[212:215], v[136:137], v[178:179], v[212:215]
    v_mfma_f32_16x16x16_bf16 v[216:219], v[136:137], v[180:181], v[216:219]
    v_mfma_f32_16x16x16_bf16 v[220:223], v[136:137], v[182:183], v[220:223]
    v_mfma_f32_16x16x16_bf16 v[224:227], v[136:137], v[184:185], v[224:227]
    v_mfma_f32_16x16x16_bf16 v[200:203], v[138:139], v[186:187], v[200:203]
    v_mfma_f32_16x16x16_bf16 v[204:207], v[138:139], v[188:189], v[204:207]
    v_mfma_f32_16x16x16_bf16 v[208:211], v[138:139], v[190:191], v[208:211]
    v_mfma_f32_16x16x16_bf16 v[212:215], v[138:139], v[192:193], v[212:215]
    v_mfma_f32_16x16x16_bf16 v[216:219], v[138:139], v[194:195], v[216:219]
    v_mfma_f32_16x16x16_bf16 v[220:223], v[138:139], v[196:197], v[220:223]
    v_mfma_f32_16x16x16_bf16 v[224:227], v[138:139], v[198:199], v[224:227]
    s_nop 7
    v_mul_f32 v200, v15, v200
    v_mul_f32 v204, v15, v204
    v_mul_f32 v208, v15, v208
    v_mul_f32 v212, v15, v212
    v_mul_f32 v216, v15, v216
    v_mul_f32 v220, v15, v220
    v_mul_f32 v224, v15, v224
L_noffn2:
    v_mul_u32_u24 v8, 448, v13
    v_lshl_add_u32 v8, v12, 2, v8
    v_add_u32 v8, 0xe000, v8
    ds_write_b32 v8, v200 offset:0
    ds_write_b32 v8, v204 offset:64
    ds_write_b32 v8, v208 offset:128
    ds_write_b32 v8, v212 offset:192
    ds_write_b32 v8, v216 offset:256
    ds_write_b32 v8, v220 offset:320
    ds_write_b32 v8, v224 offset:384
    v_mov_b32 v8, 0x4460
    s_mov_b32 s70, 0x40000
L_wfl:
    s_sleep 16
    ds_read_b32 v9, v8
    s_waitcnt lgkmcnt(0)
    v_readfirstlane_b32 s68, v9
    s_sub_u32 s70, s70, 1
    s_cmp_eq_u32 s70, 0
    s_cbranch_scc1 L_wfd
    s_cmp_lt_u32 s68, 1472
    s_cbranch_scc1 L_wfl
L_wfd:
    s_mov_b32 s70, 0x40000
L_poll55:
    buffer_load_dwordx4 v[144:147], v11, s[36:39], 0 offen sc1
    s_waitcnt vmcnt(0)
    v_bitop3_b32 v148, v144, v145, v146 bitop3:0x96
    v_cmp_ne_u32_e64 s[72:73], s58, v148
    s_cmp_eq_u64 s[72:73], 0
    s_cbranch_scc1 L_pdone56
    s_mov_b64 exec, s[72:73]
    s_sleep 16
    s_sub_u32 s70, s70, 1
    s_cmp_lg_u32 s70, 0
    s_cbranch_scc1 L_poll55
L_pdone56:
    s_mov_b64 exec, -1
    v_mov_b32 v148, v144
    s_nop 1
    v_max_f32_dpp v148, v148, v148 row_ror:8 row_mask:0xf bank_mask:0xf
    s_nop 1
    v_max_f32_dpp v148, v148, v148 row_ror:4 row_mask:0xf bank_mask:0xf
    s_nop 1
    v_max_f32_dpp v148, v148, v148 row_ror:2 row_mask:0xf bank_mask:0xf
    v_mov_b32 v149, v148
    s_nop 1
    v_permlane16_swap_b32 v148, v149
    s_nop 0
    v_max_f32 v148, v148, v149
    v_sub_f32 v144, v144, v148
    v_exp_f32 v144, v144
    s_nop 0
    v_mul_f32 v145, v145, v144
    s_nop 1
    v_add_f32_dpp v145, v145, v145 row_ror:8 row_mask:0xf bank_mask:0xf
    s_nop 1
    v_add_f32_dpp v145, v145, v145 row_ror:4 row_mask:0xf bank_mask:0xf
    s_nop 1
    v_add_f32_dpp v145, v145, v145 row_ror:2 row_mask:0xf bank_mask:0xf
    v_mov_b32 v149, v145
    s_nop 1
    v_permlane16_swap_b32 v145, v149
    s_nop 0
    v_add_f32 v145, v145, v149
    v_rcp_f32 v145, v145
    v_sub_f32 v140, v232, v148
    v_sub_f32 v141, v234, v148
    v_sub_f32 v142, v236, v148
    v_sub_f32 v143, v238, v148
    v_exp_f32 v140, v140
    v_exp_f32 v141, v141
    v_exp_f32 v142, v142
    v_exp_f32 v143, v143
    s_nop 0
    v_mul_f32 v140, v140, v145
    v_mul_f32 v141, v141, v145
    v_mul_f32 v142, v142, v145
    v_mul_f32 v143, v143, v145
    v_lshlrev_b32 v8, 4, v7
    v_add_u32 v8, 0x4420, v8
    s_mov_b64 exec, 3
    ds_write_b128 v8, v[140:143]
    s_mov_b64 exec, -1
    s_lshr_b32 s78, s55, 1
    s_lshl_b32 s78, s78, 2
    s_and_b32 s69, s55, 1
    s_add_u32 s78, s78, s69
    s_lshl_b32 s69, s57, 1
    s_add_u32 s78, s78, s69
    s_cmp_ge_u32 s57, 2
    s_cselect_b32 s78, 28, s78
    s_mov_b32 s32, s24
    s_mov_b32 s33, s25
    s_mov_b32 s34, 0x700
    s_mov_b32 s35, 0x00020000
    s_lshl_b32 s69, s78, 5
    s_mul_i32 s71, s56, 896
    s_add_u32 s69, s69, s71
    v_lshlrev_b32 v9, 1, v12
    v_add_u32 v9, s69, v9
    v_lshlrev_b32 v10, 4, v12
    v_add_u32 v10, 0x4500, v10
    s_lshl_b32 s69, s54, 4
    s_add_u32 s69, s69, s55
    s_lshl_b32 s69, s69, 11
    s_add_u32 s69, s69, 0x80000
    v_lshlrev_b32 v16, 7, v12
    v_lshl_or_b32 v16, v13, 5, v16
    v_add_u32 v16, s69, v16
    v_lshlrev_b32 v17, 5, v13
    s_lshl_b32 s69, s55, 7
    s_add_u32 s69, s69, 0x5000
    v_add_u32 v17, s69, v17
    s_lshr_b32 s69, s55, 3
    s_lshl_b32 s69, s69, 4
    s_add_u32 s69, s69, 0x4420
    v_mov_b32 v18, s69
    v_lshlrev_b32 v19, 4, v13
    v_add_u32 v19, 0xe980, v19
    s_lshl_b32 s44, 0x10001, s55
    s_not_b32 s44, s44
    s_mov_b32 s45, s44
    s_waitcnt lgkmcnt(0)
    s_barrier
    ds_read_b128 v[200:203], v17 offset:0
    ds_read_b128 v[204:207], v17 offset:16
    ds_read_b128 v[208:211], v17 offset:2048
    ds_read_b128 v[212:215], v17 offset:2064
    ds_read_b128 v[216:219], v17 offset:4096
    ds_read_b128 v[220:223], v17 offset:4112
    ds_read_b128 v[224:227], v17 offset:6144
    ds_read_b128 v[228:231], v17 offset:6160
    ds_read_b128 v[232:235], v18
    s_barrier
    s_mov_b32 s40, s12
    s_mov_b32 s41, s13
    s_mov_b32 s42, 0x380000
    s_mov_b32 s43, 0x00020000
    s_mul_i32 s68, s67, 28672
    s_mov_b32 m0, 0x10800
    s_add_u32 s71, s68, 0x800
    buffer_load_dwordx4 v2, s[40:43], s71 offen nt lds
    s_mov_b32 m0, 0x10c00
    s_add_u32 s71, s68, 0xc00
    buffer_load_dwordx4 v2, s[40:43], s71 offen nt lds
    s_mov_b32 m0, 0x11000
    s_add_u32 s71, s68, 0x1000
    buffer_load_dwordx4 v2, s[40:43], s71 offen nt lds
    s_mov_b32 m0, 0x11400
    s_add_u32 s71, s68, 0x1400
    buffer_load_dwordx4 v2, s[40:43], s71 offen nt lds
    s_mov_b32 m0, 0x11800
    s_add_u32 s71, s68, 0x1800
    buffer_load_dwordx4 v2, s[40:43], s71 offen nt lds
    s_mov_b32 m0, 0x11c00
    s_add_u32 s71, s68, 0x1c00
    buffer_load_dwordx4 v2, s[40:43], s71 offen nt lds
    s_mov_b32 m0, 0x12000
    s_add_u32 s71, s68, 0x2000
    buffer_load_dwordx4 v2, s[40:43], s71 offen nt lds
    s_mov_b32 m0, 0x12400
    s_add_u32 s71, s68, 0x2400
    buffer_load_dwordx4 v2, s[40:43], s71 offen nt lds
    s_mov_b32 m0, 0x12800
    s_add_u32 s71, s68, 0x2800
    buffer_load_dwordx4 v2, s[40:43], s71 offen nt lds
    s_mov_b32 m0, 0x12c00
    s_add_u32 s71, s68, 0x2c00
    buffer_load_dwordx4 v2, s[40:43], s71 offen nt lds
    s_mov_b32 m0, 0x13000
    s_add_u32 s71, s68, 0x3000
    buffer_load_dwordx4 v2, s[40:43], s71 offen nt lds
    s_mov_b32 m0, 0x13400
    s_add_u32 s71, s68, 0x3400
    buffer_load_dwordx4 v2, s[40:43], s71 offen nt lds
    s_mov_b32 m0, 0x13800
    s_add_u32 s71, s68, 0x3800
    buffer_load_dwordx4 v2, s[40:43], s71 offen nt lds
    s_mov_b32 m0, 0x13c00
    s_add_u32 s71, s68, 0x3c00
    buffer_load_dwordx4 v2, s[40:43], s71 offen nt lds
    s_mov_b32 m0, 0x14000
    s_add_u32 s71, s68, 0x4000
    buffer_load_dwordx4 v2, s[40:43], s71 offen nt lds
    s_mov_b32 m0, 0x14400
    s_add_u32 s71, s68, 0x4400
    buffer_load_dwordx4 v2, s[40:43], s71 offen nt lds
    s_mov_b32 m0, 0x14800
    s_add_u32 s71, s68, 0x4800
    buffer_load_dwordx4 v2, s[40:43], s71 offen nt lds
    s_mov_b32 m0, 0x14c00
    s_add_u32 s71, s68, 0x4c00
    buffer_load_dwordx4 v2, s[40:43], s71 offen nt lds
    s_mov_b32 m0, 0x15000
    s_add_u32 s71, s68, 0x5000
    buffer_load_dwordx4 v2, s[40:43], s71 offen nt lds
    s_mov_b32 m0, 0x15400
    s_add_u32 s71, s68, 0x5400
    buffer_load_dwordx4 v2, s[40:43], s71 offen nt lds
    s_mov_b32 m0, 0x15800
    s_add_u32 s71, s68, 0x5800
    buffer_load_dwordx4 v2, s[40:43], s71 offen nt lds
    s_mov_b32 m0, 0x15c00
    s_add_u32 s71, s68, 0x5c00
    buffer_load_dwordx4 v2, s[40:43], s71 offen nt lds
    s_mov_b32 m0, 0x16000
    s_add_u32 s71, s68, 0x6000
    buffer_load_dwordx4 v2, s[40:43], s71 offen nt lds
    s_mov_b32 m0, 0x16400
    s_add_u32 s71, s68, 0x6400
    buffer_load_dwordx4 v2, s[40:43], s71 offen nt lds
    s_mov_b32 m0, 0x16800
    s_add_u32 s71, s68, 0x6800
    buffer_load_dwordx4 v2, s[40:43], s71 offen nt lds
    s_mov_b32 m0, 0x16c00
    s_add_u32 s71, s68, 0x6c00
    buffer_load_dwordx4 v2, s[40:43], s71 offen nt lds
    s_mov_b64 exec, s[44:45]
    buffer_load_dwordx4 v[96:99], v16, s[36:39], 0 offen offset:0 sc1
    buffer_load_dwordx4 v[100:103], v16, s[36:39], 0 offen offset:16 sc1
    s_mov_b64 exec, -1
    s_waitcnt lgkmcnt(0)
    v_pk_mul_f32 v[200:201], v[200:201], v[232:233] op_sel:[0,0] op_sel_hi:[1,0]
    v_pk_mul_f32 v[202:203], v[202:203], v[232:233] op_sel:[0,0] op_sel_hi:[1,0]
    v_pk_mul_f32 v[204:205], v[204:205], v[232:233] op_sel:[0,0] op_sel_hi:[1,0]
    v_pk_mul_f32 v[206:207], v[206:207], v[232:233] op_sel:[0,0] op_sel_hi:[1,0]
    v_pk_fma_f32 v[200:201], v[208:209], v[232:233], v[200:201] op_sel:[0,1,0] op_sel_hi:[1,1,1]
    v_pk_fma_f32 v[202:203], v[210:211], v[232:233], v[202:203] op_sel:[0,1,0] op_sel_hi:[1,1,1]
    v_pk_fma_f32 v[204:205], v[212:213], v[232:233], v[204:205] op_sel:[0,1,0] op_sel_hi:[1,1,1]
    v_pk_fma_f32 v[206:207], v[214:215], v[232:233], v[206:207] op_sel:[0,1,0] op_sel_hi:[1,1,1]
    v_pk_fma_f32 v[200:201], v[216:217], v[234:235], v[200:201] op_sel:[0,0,0] op_sel_hi:[1,0,1]
    v_pk_fma_f32 v[202:203], v[218:219], v[234:235], v[202:203] op_sel:[0,0,0] op_sel_hi:[1,0,1]
    v_pk_fma_f32 v[204:205], v[220:221], v[234:235], v[204:205] op_sel:[0,0,0] op_sel_hi:[1,0,1]
    v_pk_fma_f32 v[206:207], v[222:223], v[234:235], v[206:207] op_sel:[0,0,0] op_sel_hi:[1,0,1]
    v_pk_fma_f32 v[200:201], v[224:225], v[234:235], v[200:201] op_sel:[0,1,0] op_sel_hi:[1,1,1]
    v_pk_fma_f32 v[202:203], v[226:227], v[234:235], v[202:203] op_sel:[0,1,0] op_sel_hi:[1,1,1]
    v_pk_fma_f32 v[204:205], v[228:229], v[234:235], v[204:205] op_sel:[0,1,0] op_sel_hi:[1,1,1]
    v_pk_fma_f32 v[206:207], v[230:231], v[234:235], v[206:207] op_sel:[0,1,0] op_sel_hi:[1,1,1]
    s_waitcnt vmcnt(2)
    s_barrier
    s_mov_b64 exec, s[44:45]
    s_mov_b32 s70, 0x40000
    s_branch L_pent59
L_poll57:
    buffer_load_dwordx4 v[96:99], v16, s[36:39], 0 offen offset:0 sc1
    buffer_load_dwordx4 v[100:103], v16, s[36:39], 0 offen offset:16 sc1
L_pent59:
    s_waitcnt vmcnt(0)
    v_bitop3_b32 v112, v96, v97, v98 bitop3:0x96
    v_xor_b32 v112, v112, v99
    v_cmp_ne_u32_e64 s[72:73], s58, v112
    v_bitop3_b32 v113, v100, v101, v102 bitop3:0x96
    v_xor_b32 v113, v113, v103
    v_cmp_ne_u32_e64 s[74:75], s58, v113
    s_or_b64 s[72:73], s[72:73], s[74:75]
    s_cmp_eq_u64 s[72:73], 0
    s_cbranch_scc1 L_pdone58
    s_mov_b64 exec, s[72:73]
    s_sub_u32 s70, s70, 1
    s_cmp_lg_u32 s70, 0
    s_cbranch_scc1 L_poll57
L_pdone58:
    s_mov_b64 exec, -1
    v_perm_b32 v99, v98, v97, s46
    v_perm_b32 v103, v102, v101, s46
    v_perm_b32 v99, v99, v96, s47
    v_perm_b32 v103, v103, v100, s47
    v_cndmask_b32_e64 v96, v200, v96, s[44:45]
    v_cndmask_b32_e64 v97, v201, v97, s[44:45]
    v_cndmask_b32_e64 v98, v202, v98, s[44:45]
    v_cndmask_b32_e64 v99, v203, v99, s[44:45]
    v_cndmask_b32_e64 v100, v204, v100, s[44:45]
    v_cndmask_b32_e64 v101, v205, v101, s[44:45]
    v_cndmask_b32_e64 v102, v206, v102, s[44:45]
    v_cndmask_b32_e64 v103, v207, v103, s[44:45]
    s_nop 1
    v_add_f32_dpp v96, v96, v96 row_ror:8 row_mask:0xf bank_mask:0xf
    v_add_f32_dpp v97, v97, v97 row_ror:8 row_mask:0xf bank_mask:0xf
    v_add_f32_dpp v98, v98, v98 row_ror:8 row_mask:0xf bank_mask:0xf
    v_add_f32_dpp v99, v99, v99 row_ror:8 row_mask:0xf bank_mask:0xf
    v_add_f32_dpp v100, v100, v100 row_ror:8 row_mask:0xf bank_mask:0xf
    v_add_f32_dpp v101, v101, v101 row_ror:8 row_mask:0xf bank_mask:0xf
    v_add_f32_dpp v102, v102, v102 row_ror:8 row_mask:0xf bank_mask:0xf
    v_add_f32_dpp v103, v103, v103 row_ror:8 row_mask:0xf bank_mask:0xf
    v_add_f32_dpp v96, v96, v96 row_ror:4 row_mask:0xf bank_mask:0xf
    v_add_f32_dpp v97, v97, v97 row_ror:4 row_mask:0xf bank_mask:0xf
    v_add_f32_dpp v98, v98, v98 row_ror:4 row_mask:0xf bank_mask:0xf
    v_add_f32_dpp v99, v99, v99 row_ror:4 row_mask:0xf bank_mask:0xf
    v_add_f32_dpp v100, v100, v100 row_ror:4 row_mask:0xf bank_mask:0xf
    v_add_f32_dpp v101, v101, v101 row_ror:4 row_mask:0xf bank_mask:0xf
    v_add_f32_dpp v102, v102, v102 row_ror:4 row_mask:0xf bank_mask:0xf
    v_add_f32_dpp v103, v103, v103 row_ror:4 row_mask:0xf bank_mask:0xf
    v_add_f32_dpp v96, v96, v96 row_ror:2 row_mask:0xf bank_mask:0xf
    v_add_f32_dpp v97, v97, v97 row_ror:2 row_mask:0xf bank_mask:0xf
    v_add_f32_dpp v98, v98, v98 row_ror:2 row_mask:0xf bank_mask:0xf
    v_add_f32_dpp v99, v99, v99 row_ror:2 row_mask:0xf bank_mask:0xf
    v_add_f32_dpp v100, v100, v100 row_ror:2 row_mask:0xf bank_mask:0xf
    v_add_f32_dpp v101, v101, v101 row_ror:2 row_mask:0xf bank_mask:0xf
    v_add_f32_dpp v102, v102, v102 row_ror:2 row_mask:0xf bank_mask:0xf
    v_add_f32_dpp v103, v103, v103 row_ror:2 row_mask:0xf bank_mask:0xf
    v_add_f32_dpp v96, v96, v96 row_ror:1 row_mask:0xf bank_mask:0xf
    v_add_f32_dpp v97, v97, v97 row_ror:1 row_mask:0xf bank_mask:0xf
    v_add_f32_dpp v98, v98, v98 row_ror:1 row_mask:0xf bank_mask:0xf
    v_add_f32_dpp v99, v99, v99 row_ror:1 row_mask:0xf bank_mask:0xf
    v_add_f32_dpp v100, v100, v100 row_ror:1 row_mask:0xf bank_mask:0xf
    v_add_f32_dpp v101, v101, v101 row_ror:1 row_mask:0xf bank_mask:0xf
    v_add_f32_dpp v102, v102, v102 row_ror:1 row_mask:0xf bank_mask:0xf
    v_add_f32_dpp v103, v103, v103 row_ror:1 row_mask:0xf bank_mask:0xf
    v_cvt_pk_bf16_f32 v116, v96, v97
    v_cvt_pk_bf16_f32 v117, v98, v99
    v_cvt_pk_bf16_f32 v118, v100, v101
    v_cvt_pk_bf16_f32 v119, v102, v103
    ds_write_b128 v19, v[116:119]
    s_waitcnt lgkmcnt(0)
    s_barrier
    s_cmp_ge_u32 s78, 28
    s_cbranch_scc1 L_hend
    s_barrier
    ds_read_b128 v[128:131], v10
    s_waitcnt lgkmcnt(0)
    v_add_f32 v128, v128, v129
    v_add_f32 v130, v130, v131
    v_add_f32 v128, v128, v130
    v_cvt_pk_bf16_f32 v128, v128, v128
    s_mov_b64 exec, 0xffff
    buffer_store_short v128, v9, s[32:35], 0 offen
    s_or_b32 s68, s56, s78
    s_cmp_lg_u32 s68, 0
    s_cbranch_scc1 L_hend
    s_mov_b64 exec, 1
    v_mov_b32 v130, s76
    v_mov_b32 v131, 0
    buffer_store_dword v130, v131, s[36:39], 0 offen
L_hend:
    s_endpgm
L_gov:
    s_setprio 2
    v_mov_b32 v8, 0
    v_and_b32 v13, 3, v0
    v_lshlrev_b32 v13, 2, v13
    v_add_u32 v13, 0x4460, v13
    ds_write_b32 v13, v8
    v_mov_b32 v1, 0x2492
    ds_write_b32 v13, v1 offset:16
    v_mov_b32 v6, 0x4400
    s_and_b32 s66, s2, 7
    s_lshr_b32 s67, s2, 3
    s_add_u32 s68, s66, 0
    s_and_b32 s68, s68, 7
    s_add_u32 s69, s67, 0
    s_and_b32 s69, s69, 7
    s_lshl_b32 s69, s69, 3
    s_or_b32 s68, s68, s69
    s_mul_i32 s32, s68, 4352
    s_add_u32 s32, s32, 0x180000
    s_add_u32 s68, s66, 1
    s_and_b32 s68, s68, 7
    s_add_u32 s69, s67, 3
    s_and_b32 s69, s69, 7
    s_lshl_b32 s69, s69, 3
    s_or_b32 s68, s68, s69
    s_mul_i32 s33, s68, 4352
    s_add_u32 s33, s33, 0x180000
    s_add_u32 s68, s66, 2
    s_and_b32 s68, s68, 7
    s_add_u32 s69, s67, 6
    s_and_b32 s69, s69, 7
    s_lshl_b32 s69, s69, 3
    s_or_b32 s68, s68, s69
    s_mul_i32 s34, s68, 4352
    s_add_u32 s34, s34, 0x180000
    s_add_u32 s68, s66, 3
    s_and_b32 s68, s68, 7
    s_add_u32 s69, s67, 9
    s_and_b32 s69, s69, 7
    s_lshl_b32 s69, s69, 3
    s_or_b32 s68, s68, s69
    s_mul_i32 s35, s68, 4352
    s_add_u32 s35, s35, 0x180000
    s_add_u32 s68, s66, 4
    s_and_b32 s68, s68, 7
    s_add_u32 s69, s67, 12
    s_and_b32 s69, s69, 7
    s_lshl_b32 s69, s69, 3
    s_or_b32 s68, s68, s69
    s_mul_i32 s36, s68, 4352
    s_add_u32 s36, s36, 0x180000
    s_add_u32 s68, s66, 5
    s_and_b32 s68, s68, 7
    s_add_u32 s69, s67, 15
    s_and_b32 s69, s69, 7
    s_lshl_b32 s69, s69, 3
    s_or_b32 s68, s68, s69
    s_mul_i32 s37, s68, 4352
    s_add_u32 s37, s37, 0x180000
    s_add_u32 s68, s66, 6
    s_and_b32 s68, s68, 7
    s_add_u32 s69, s67, 18
    s_and_b32 s69, s69, 7
    s_lshl_b32 s69, s69, 3
    s_or_b32 s68, s68, s69
    s_mul_i32 s38, s68, 4352
    s_add_u32 s38, s38, 0x180000
    s_add_u32 s68, s66, 7
    s_and_b32 s68, s68, 7
    s_add_u32 s69, s67, 21
    s_and_b32 s69, s69, 7
    s_lshl_b32 s69, s69, 3
    s_or_b32 s68, s68, s69
    s_mul_i32 s39, s68, 4352
    s_add_u32 s39, s39, 0x180000
    v_lshlrev_b32 v7, 4, v0
    v_add_u32 v7, s32, v7
    s_waitcnt lgkmcnt(0)
    s_mov_b32 s48, s28
    s_mov_b32 s49, s29
    s_mov_b32 s50, 0x200000
    s_mov_b32 s51, 0x00020000
    s_barrier
    ds_read_b32 v1, v6
    s_waitcnt lgkmcnt(0)
    v_readfirstlane_b32 s58, v1
    s_mov_b64 exec, 0xff
    s_and_b32 s59, s67, 7
    s_add_u32 s72, s66, s67
    s_mov_b32 s61, 0
    s_mov_b32 s74, -5120
    s_mov_b32 s75, 4200
    s_mov_b32 s63, 1
    s_mov_b32 s70, 0x100000
L_gl:
    s_sub_u32 s70, s70, 1
    s_cmp_eq_u32 s70, 0
    s_cbranch_scc1 L_gx
    s_sleep 16
    ds_read_b32 v12, v13
    s_waitcnt lgkmcnt(0)
    v_readlane_b32 s65, v12, 1
    s_add_u32 s74, s74, s75
    s_lshr_b32 s60, s65, 5
    s_add_u32 s66, s60, s59
    s_lshr_b32 s66, s66, 3
    s_cmp_eq_u32 s66, s61
    s_cbranch_scc1 L_gnp
    s_mov_b32 s61, s66
    s_cmp_ge_u32 s67, 8
    s_cbranch_scc1 L_gnp
    s_add_u32 s66, s66, s58
    v_mov_b32 v8, s66
    v_mov_b32 v9, s66
    v_mov_b32 v10, s66
    v_mov_b32 v11, s66
    buffer_store_dwordx4 v[8:11], v7, s[48:51], 0 offen sc1
L_gnp:
    s_cmp_ge_u32 s60, 59
    s_cbranch_scc1 L_gx
    s_add_u32 s72, s72, 1
    s_and_b32 s66, s72, 7
    s_cbranch_scc1 L_gref
    s_load_dword s80, s[28:29], s32 glc
    s_load_dword s81, s[28:29], s33 glc
    s_load_dword s82, s[28:29], s34 glc
    s_load_dword s83, s[28:29], s35 glc
    s_load_dword s84, s[28:29], s36 glc
    s_load_dword s85, s[28:29], s37 glc
    s_load_dword s86, s[28:29], s38 glc
    s_load_dword s87, s[28:29], s39 glc
    s_waitcnt lgkmcnt(0)
    s_sub_u32 s80, s80, s58
    s_cmp_le_u32 s80, 9
    s_cselect_b32 s80, s80, 0
    s_sub_u32 s81, s81, s58
    s_cmp_le_u32 s81, 9
    s_cselect_b32 s81, s81, 0
    s_sub_u32 s82, s82, s58
    s_cmp_le_u32 s82, 9
    s_cselect_b32 s82, s82, 0
    s_sub_u32 s83, s83, s58
    s_cmp_le_u32 s83, 9
    s_cselect_b32 s83, s83, 0
    s_sub_u32 s84, s84, s58
    s_cmp_le_u32 s84, 9
    s_cselect_b32 s84, s84, 0
    s_sub_u32 s85, s85, s58
    s_cmp_le_u32 s85, 9
    s_cselect_b32 s85, s85, 0
    s_sub_u32 s86, s86, s58
    s_cmp_le_u32 s86, 9
    s_cselect_b32 s86, s86, 0
    s_sub_u32 s87, s87, s58
    s_cmp_le_u32 s87, 9
    s_cselect_b32 s87, s87, 0
    s_add_u32 s80, s80, s81
    s_add_u32 s80, s80, s82
    s_add_u32 s80, s80, s83
    s_add_u32 s80, s80, s84
    s_add_u32 s80, s80, s85
    s_add_u32 s80, s80, s86
    s_add_u32 s80, s80, s87
    s_mul_i32 s80, s80, 8192
    s_sub_u32 s80, s80, s74
    s_ashr_i32 s66, s80, s63
    s_add_u32 s74, s74, s66
    s_ashr_i32 s66, s80, 7
    s_add_u32 s75, s75, s66
    s_cmp_ge_u32 s60, 30
    s_cselect_b32 s63, 2, 1
    s_ashr_i32 s80, s74, 8
    s_mul_i32 s66, s75, 4
    s_ashr_i32 s66, s66, 2
    s_add_u32 s74, s74, s66
    s_branch L_gm
L_gref:
    s_ashr_i32 s80, s74, 8
L_gm:
    v_sub_u32 v12, s80, v12
    v_mov_b32 v1, 0xffff
    v_cmp_le_i32 vcc, -32, v12
    v_mov_b32 v2, 0x7777
    s_nop 0
    v_cndmask_b32 v1, v1, v2, vcc
    v_cmp_le_i32 vcc, -16, v12
    v_mov_b32 v2, 0x5555
    s_nop 0
    v_cndmask_b32 v1, v1, v2, vcc
    v_cmp_le_i32 vcc, 4, v12
    v_mov_b32 v2, 0x2492
    s_nop 0
    v_cndmask_b32 v1, v1, v2, vcc
    v_cmp_le_i32 vcc, 32, v12
    v_mov_b32 v2, 0x0
    s_nop 0
    v_cndmask_b32 v1, v1, v2, vcc
    ds_write_b32 v13, v1 offset:16
    s_branch L_gl
L_gx:
    s_endpgm
L_stream:
    s_mov_b32 s36, s28
    s_mov_b32 s37, s29
    s_mov_b32 s38, 0x200000
    s_mov_b32 s39, 0x00020000
    s_add_u32 s40, s8, s67
    s_addc_u32 s41, s9, 0
    s_mov_b32 s42, 0x200000
    s_mov_b32 s43, 0x00020000
    s_mov_b32 s48, 0x7060501
    s_mov_b32 s49, 0x7060502
    s_mov_b32 s50, 0x7060503
    s_mov_b32 s46, 0x04000c0c
    s_mov_b32 s47, 0x0706000c
    s_mov_b32 s64, 0x00ff00ff
    s_mov_b32 s65, 0x00ff00ff
    s_lshl_b32 s68, s3, 12
    v_lshlrev_b32 v4, 4, v14
    v_add_u32 v4, s68, v4
    v_lshlrev_b32 v2, 4, v0
    v_lshrrev_b32 v50, 5, v0
    v_lshlrev_b32 v5, 4, v50
    v_add_u32 v5, s68, v5
    s_lshl_b32 s69, s3, 11
    s_add_u32 s69, s69, 0x5000
    v_lshlrev_b32 v9, 5, v0
    v_add_u32 v9, s69, v9
    v_and_b32 v50, 31, v0
    v_lshlrev_b32 v10, 4, v50
    s_lshl_b32 s69, s3, 9
    s_add_u32 s69, s69, 0x5000
    v_add_u32 v10, s69, v10
    s_lshr_b32 s69, s3, 1
    s_lshl_b32 s69, s69, 4
    s_add_u32 s69, s69, 0x4420
    v_mov_b32 v60, s69
    v_lshrrev_b32 v6, 3, v50
    v_lshlrev_b32 v6, 11, v6
    v_and_b32 v50, 7, v0
    v_lshl_add_u32 v6, v50, 4, v6
    s_lshl_b32 s69, s54, 4
    s_lshl_b32 s71, s3, 2
    s_add_u32 s69, s69, s71
    s_lshl_b32 s69, s69, 11
    s_lshl_b32 s71, s55, 7
    s_add_u32 s69, s69, s71
    s_add_u32 s69, s69, 0x80000
    v_add_u32 v6, s69, v6
    v_lshlrev_b32 v50, 6, v12
    v_lshl_add_u32 v50, v13, 4, v50
    v_add_u32 v7, 0xe800, v50
    s_lshl_b32 s69, s54, 4
    s_add_u32 s69, s69, s55
    s_lshl_b32 s69, s69, 11
    s_lshl_b32 s71, s3, 9
    s_add_u32 s69, s69, s71
    s_add_u32 s69, s69, 0x100000
    v_add_u32 v8, s69, v50
    s_mul_i32 s69, s3, 448
    s_add_u32 s69, s69, 0xe000
    v_add_u32 v3, s69, v50
    v_lshrrev_b32 v50, 2, v12
    v_lshl_add_u32 v50, v13, 3, v50
    v_mul_u32_u24 v11, 896, v50
    v_and_b32 v50, 3, v12
    v_lshl_add_u32 v11, v50, 3, v11
    s_mul_i32 s69, s3, 224
    s_add_u32 s69, s69, 0x10000
    v_add_u32 v11, s69, v11
    s_lshr_b32 s44, s55, 1
    s_lshl_b32 s44, s44, 2
    s_and_b32 s69, s55, 1
    s_add_u32 s44, s44, s69
    s_lshl_b32 s69, s57, 1
    s_add_u32 s44, s44, s69
    s_cmp_ge_u32 s57, 2
    s_cselect_b32 s44, 28, s44
    s_mul_i32 s69, s44, 37
    s_lshr_b32 s69, s69, 8
    s_add_u32 s69, s69, s44
    s_lshl_b32 s69, s69, 6
    s_lshl_b32 s71, s56, 18
    s_add_u32 s69, s69, s71
    s_lshl_b32 s71, s3, 16
    s_add_u32 s69, s69, s71
    s_add_u32 s69, s69, 0x100000
    v_lshrrev_b32 v44, 2, v0
    v_lshlrev_b32 v44, 11, v44
    v_lshl_add_u32 v44, v50, 4, v44
    v_add_u32 v44, s69, v44
    s_mov_b32 s45, 0x8000
    v_lshl_add_u32 v45, v50, 2, v13
    v_lshlrev_b32 v45, 4, v45
    s_lshl_b32 s69, s3, 2
    s_add_u32 s71, s69, 0x4500
    v_add_u32 v45, s71, v45
    s_add_u32 s71, s69, 0x4460
    v_mov_b32 v49, s71
    v_mov_b32 v46, 0
    v_mov_b32 v48, 0
    v_and_b32 v50, 1, v14
    v_lshlrev_b32 v12, 9, v50
    v_lshl_or_b32 v12, v15, 6, v12
    v_lshl_or_b32 v12, v13, 4, v12
    v_add_u32 v12, 0x4000, v12
    v_mov_b32 v63, 0x4400
    v_add_u32 v14, s68, v2
    s_lshl_b32 s69, s3, 4
    s_add_u32 s69, s69, 0x4480
    v_mov_b32 v15, s69
    s_waitcnt vmcnt(5)
    buffer_load_dwordx4 v[152:155], v1, s[32:35], s61 offen offset:256 nt
    s_waitcnt vmcnt(5)
    buffer_load_dwordx4 v[156:159], v1, s[32:35], s61 offen offset:384 nt
    s_add_u32 s60, s60, 0x10000
    s_add_u32 s61, s60, 4096
    s_waitcnt vmcnt(5)
    buffer_load_dwordx4 v[160:163], v1, s[32:35], s60 offen offset:0 nt
    s_waitcnt vmcnt(5)
    buffer_load_dwordx4 v[164:167], v1, s[32:35], s60 offen offset:128 nt
    s_waitcnt vmcnt(5)
    buffer_load_dwordx4 v[168:171], v1, s[32:35], s60 offen offset:256 nt
    s_waitcnt vmcnt(5)
    buffer_load_dwordx4 v[172:175], v1, s[32:35], s60 offen offset:384 nt
    s_waitcnt vmcnt(5)
    buffer_load_dwordx4 v[176:179], v1, s[32:35], s61 offen offset:0 nt
    s_waitcnt vmcnt(5)
    buffer_load_dwordx4 v[180:183], v1, s[32:35], s61 offen offset:128 nt
    s_waitcnt vmcnt(5)
    buffer_load_dwordx4 v[184:187], v1, s[32:35], s61 offen offset:256 nt
    s_waitcnt vmcnt(5)
    buffer_load_dwordx4 v[188:191], v1, s[32:35], s61 offen offset:384 nt
    s_add_u32 s60, s60, 0x10000
    s_add_u32 s61, s60, 4096
    s_waitcnt vmcnt(5)
    buffer_load_dwordx4 v[192:195], v1, s[32:35], s60 offen offset:0 nt
    s_waitcnt vmcnt(5)
    buffer_load_dwordx4 v[196:199], v1, s[32:35], s60 offen offset:128 nt
    s_waitcnt vmcnt(5)
    buffer_load_dwordx4 v[200:203], v1, s[32:35], s60 offen offset:256 nt
    s_waitcnt vmcnt(5)
    buffer_load_dwordx4 v[204:207], v1, s[32:35], s60 offen offset:384 nt
    s_waitcnt vmcnt(5)
    buffer_load_dwordx4 v[208:211], v1, s[32:35], s61 offen offset:0 nt
    s_waitcnt vmcnt(5)
    buffer_load_dwordx4 v[212:215], v1, s[32:35], s61 offen offset:128 nt
    s_waitcnt vmcnt(5)
    buffer_load_dwordx4 v[216:219], v1, s[32:35], s61 offen offset:256 nt
    s_waitcnt vmcnt(5)
    buffer_load_dwordx4 v[220:223], v1, s[32:35], s61 offen offset:384 nt
    s_add_u32 s60, s60, 0x10000
    s_add_u32 s61, s60, 4096
    s_waitcnt vmcnt(5)
    buffer_load_dwordx4 v[224:227], v1, s[32:35], s60 offen offset:0 nt
    s_waitcnt vmcnt(5)
    buffer_load_dwordx4 v[228:231], v1, s[32:35], s60 offen offset:128 nt
    s_waitcnt vmcnt(5)
    buffer_load_dwordx4 v[232:235], v1, s[32:35], s60 offen offset:256 nt
    s_waitcnt vmcnt(5)
    buffer_load_dwordx4 v[236:239], v1, s[32:35], s60 offen offset:384 nt
    s_waitcnt vmcnt(5)
    buffer_load_dwordx4 v[240:243], v1, s[32:35], s61 offen offset:0 nt
    s_waitcnt vmcnt(5)
    buffer_load_dwordx4 v[244:247], v1, s[32:35], s61 offen offset:128 nt
    s_waitcnt vmcnt(5)
    buffer_load_dwordx4 v[248:251], v1, s[32:35], s61 offen offset:256 nt
    s_waitcnt vmcnt(5)
    buffer_load_dwordx4 v[252:255], v1, s[32:35], s61 offen offset:384 nt
    s_add_u32 s60, s60, 0x10000
    s_barrier
    ds_read_b128 v[16:19], v12 offset:0
    ds_read_b128 v[20:23], v12 offset:128
    ds_read_b128 v[24:27], v12 offset:256
    ds_read_b128 v[28:31], v12 offset:384
    ds_read_b32 v13, v63
    s_mov_b32 s59, 0
    s_mov_b32 s79, 0x2492
    v_mov_b32 v62, s79
    s_waitcnt lgkmcnt(0)
    v_readfirstlane_b32 s58, v13
L_kloop:
    s_add_u32 s61, s60, 4096
    v_mfma_f32_16x16x32_bf16 v[32:35], v[16:19], v[128:131], 0
    v_mfma_f32_16x16x32_bf16 v[32:35], v[20:23], v[132:135], v[32:35]
    v_mfma_f32_16x16x32_bf16 v[32:35], v[24:27], v[136:139], v[32:35]
    v_mfma_f32_16x16x32_bf16 v[32:35], v[28:31], v[140:143], v[32:35]
    s_waitcnt vmcnt(6)
    s_bitcmp1_b32 s79, 0
    s_cbranch_scc0 L_w1
    s_waitcnt vmcnt(4)
L_w1:
    buffer_load_dwordx4 v[128:131], v1, s[32:35], s60 offen offset:0 nt
    s_waitcnt vmcnt(6)
    s_bitcmp1_b32 s79, 1
    s_cbranch_scc0 L_w2
    s_waitcnt vmcnt(4)
L_w2:
    buffer_load_dwordx4 v[132:135], v1, s[32:35], s60 offen offset:128 nt
    v_add_u32 v48, 8, v48
    ds_write_b32 v49, v48
    s_waitcnt vmcnt(6)
    s_bitcmp1_b32 s79, 2
    s_cbranch_scc0 L_w3
    s_waitcnt vmcnt(4)
L_w3:
    buffer_load_dwordx4 v[136:139], v1, s[32:35], s60 offen offset:256 nt
    s_waitcnt vmcnt(6)
    s_bitcmp1_b32 s79, 3
    s_cbranch_scc0 L_w4
    s_waitcnt vmcnt(4)
L_w4:
    buffer_load_dwordx4 v[140:143], v1, s[32:35], s60 offen offset:384 nt
    s_waitcnt lgkmcnt(0)
    v_readfirstlane_b32 s79, v62
    v_add_u32 v46, 32, v46
    v_mov_b32 v48, v46
    ds_write_b32 v49, v46
    ds_read_b32 v62, v49 offset:16
    v_add_f32_dpp v40, v33, v32 quad_perm:[1,1,3,3] row_mask:0xf bank_mask:0xf
    v_add_f32_dpp v41, v35, v34 quad_perm:[1,1,3,3] row_mask:0xf bank_mask:0xf
    v_mfma_f32_16x16x32_bf16 v[36:39], v[16:19], v[144:147], 0
    v_mfma_f32_16x16x32_bf16 v[36:39], v[20:23], v[148:151], v[36:39]
    v_mfma_f32_16x16x32_bf16 v[36:39], v[24:27], v[152:155], v[36:39]
    v_mfma_f32_16x16x32_bf16 v[36:39], v[28:31], v[156:159], v[36:39]
    s_waitcnt vmcnt(6)
    s_bitcmp1_b32 s79, 4
    s_cbranch_scc0 L_w5
    s_waitcnt vmcnt(4)
L_w5:
    buffer_load_dwordx4 v[144:147], v1, s[32:35], s61 offen offset:0 nt
    s_waitcnt vmcnt(6)
    s_bitcmp1_b32 s79, 5
    s_cbranch_scc0 L_w6
    s_waitcnt vmcnt(4)
L_w6:
    buffer_load_dwordx4 v[148:151], v1, s[32:35], s61 offen offset:128 nt
    v_add_u32 v48, 8, v48
    ds_write_b32 v49, v48
    s_waitcnt vmcnt(6)
    s_bitcmp1_b32 s79, 6
    s_cbranch_scc0 L_w7
    s_waitcnt vmcnt(4)
L_w7:
    buffer_load_dwordx4 v[152:155], v1, s[32:35], s61 offen offset:256 nt
    s_waitcnt vmcnt(6)
    s_bitcmp1_b32 s79, 7
    s_cbranch_scc0 L_w8
    s_waitcnt vmcnt(4)
L_w8:
    buffer_load_dwordx4 v[156:159], v1, s[32:35], s61 offen offset:384 nt
    v_add_u32 v48, 8, v48
    ds_write_b32 v49, v48
    v_add_f32_dpp v42, v37, v36 quad_perm:[1,1,3,3] row_mask:0xf bank_mask:0xf
    v_add_f32_dpp v43, v39, v38 quad_perm:[1,1,3,3] row_mask:0xf bank_mask:0xf
    s_mov_b64 exec, 0x5555
    ds_write_b128 v4, v[40:43] offset:0
    s_mov_b64 exec, -1
    s_add_u32 s60, s60, 0x10000
    s_add_u32 s61, s60, 4096
    v_mfma_f32_16x16x32_bf16 v[32:35], v[16:19], v[160:163], 0
    v_mfma_f32_16x16x32_bf16 v[32:35], v[20:23], v[164:167], v[32:35]
    v_mfma_f32_16x16x32_bf16 v[32:35], v[24:27], v[168:171], v[32:35]
    v_mfma_f32_16x16x32_bf16 v[32:35], v[28:31], v[172:175], v[32:35]
    s_waitcnt vmcnt(6)
    s_bitcmp1_b32 s79, 8
    s_cbranch_scc0 L_w9
    s_waitcnt vmcnt(4)
L_w9:
    buffer_load_dwordx4 v[160:163], v1, s[32:35], s60 offen offset:0 nt
    s_waitcnt vmcnt(6)
    s_bitcmp1_b32 s79, 9
    s_cbranch_scc0 L_w10
    s_waitcnt vmcnt(4)
L_w10:
    buffer_load_dwordx4 v[164:167], v1, s[32:35], s60 offen offset:128 nt
    v_add_u32 v48, 8, v48
    ds_write_b32 v49, v48
    s_waitcnt vmcnt(6)
    s_bitcmp1_b32 s79, 10
    s_cbranch_scc0 L_w11
    s_waitcnt vmcnt(4)
L_w11:
    buffer_load_dwordx4 v[168:171], v1, s[32:35], s60 offen offset:256 nt
    s_waitcnt vmcnt(6)
    s_bitcmp1_b32 s79, 11
    s_cbranch_scc0 L_w12
    s_waitcnt vmcnt(4)
L_w12:
    buffer_load_dwordx4 v[172:175], v1, s[32:35], s60 offen offset:384 nt
    s_waitcnt lgkmcnt(0)
    v_readfirstlane_b32 s79, v62
    v_add_u32 v46, 32, v46
    v_mov_b32 v48, v46
    ds_write_b32 v49, v46
    ds_read_b32 v62, v49 offset:16
    v_add_f32_dpp v40, v33, v32 quad_perm:[1,1,3,3] row_mask:0xf bank_mask:0xf
    v_add_f32_dpp v41, v35, v34 quad_perm:[1,1,3,3] row_mask:0xf bank_mask:0xf
    v_mfma_f32_16x16x32_bf16 v[36:39], v[16:19], v[176:179], 0
    v_mfma_f32_16x16x32_bf16 v[36:39], v[20:23], v[180:183], v[36:39]
    v_mfma_f32_16x16x32_bf16 v[36:39], v[24:27], v[184:187], v[36:39]
    v_mfma_f32_16x16x32_bf16 v[36:39], v[28:31], v[188:191], v[36:39]
    s_waitcnt vmcnt(6)
    s_bitcmp1_b32 s79, 12
    s_cbranch_scc0 L_w13
    s_waitcnt vmcnt(4)
L_w13:
    buffer_load_dwordx4 v[176:179], v1, s[32:35], s61 offen offset:0 nt
    s_waitcnt vmcnt(6)
    s_bitcmp1_b32 s79, 13
    s_cbranch_scc0 L_w14
    s_waitcnt vmcnt(4)
L_w14:
    buffer_load_dwordx4 v[180:183], v1, s[32:35], s61 offen offset:128 nt
    v_add_u32 v48, 8, v48
    ds_write_b32 v49, v48
    s_waitcnt vmcnt(6)
    s_bitcmp1_b32 s79, 14
    s_cbranch_scc0 L_w15
    s_waitcnt vmcnt(4)
L_w15:
    buffer_load_dwordx4 v[184:187], v1, s[32:35], s61 offen offset:256 nt
    s_waitcnt vmcnt(6)
    s_bitcmp1_b32 s79, 15
    s_cbranch_scc0 L_w16
    s_waitcnt vmcnt(4)
L_w16:
    buffer_load_dwordx4 v[188:191], v1, s[32:35], s61 offen offset:384 nt
    v_add_u32 v48, 8, v48
    ds_write_b32 v49, v48
    v_add_f32_dpp v42, v37, v36 quad_perm:[1,1,3,3] row_mask:0xf bank_mask:0xf
    v_add_f32_dpp v43, v39, v38 quad_perm:[1,1,3,3] row_mask:0xf bank_mask:0xf
    s_mov_b64 exec, 0x5555
    ds_write_b128 v4, v[40:43] offset:128
    s_mov_b64 exec, -1
    s_add_u32 s60, s60, 0x10000
    s_add_u32 s61, s60, 4096
    v_mfma_f32_16x16x32_bf16 v[32:35], v[16:19], v[192:195], 0
    v_mfma_f32_16x16x32_bf16 v[32:35], v[20:23], v[196:199], v[32:35]
    v_mfma_f32_16x16x32_bf16 v[32:35], v[24:27], v[200:203], v[32:35]
    v_mfma_f32_16x16x32_bf16 v[32:35], v[28:31], v[204:207], v[32:35]
    s_waitcnt vmcnt(6)
    s_bitcmp1_b32 s79, 0
    s_cbranch_scc0 L_w17
    s_waitcnt vmcnt(4)
L_w17:
    buffer_load_dwordx4 v[192:195], v1, s[32:35], s60 offen offset:0 nt
    s_waitcnt vmcnt(6)
    s_bitcmp1_b32 s79, 1
    s_cbranch_scc0 L_w18
    s_waitcnt vmcnt(4)
L_w18:
    buffer_load_dwordx4 v[196:199], v1, s[32:35], s60 offen offset:128 nt
    v_add_u32 v48, 8, v48
    ds_write_b32 v49, v48
    s_waitcnt vmcnt(6)
    s_bitcmp1_b32 s79, 2
    s_cbranch_scc0 L_w19
    s_waitcnt vmcnt(4)
L_w19:
    buffer_load_dwordx4 v[200:203], v1, s[32:35], s60 offen offset:256 nt
    s_waitcnt vmcnt(6)
    s_bitcmp1_b32 s79, 3
    s_cbranch_scc0 L_w20
    s_waitcnt vmcnt(4)
L_w20:
    buffer_load_dwordx4 v[204:207], v1, s[32:35], s60 offen offset:384 nt
    s_waitcnt lgkmcnt(0)
    v_readfirstlane_b32 s79, v62
    v_add_u32 v46, 32, v46
    v_mov_b32 v48, v46
    ds_write_b32 v49, v46
    ds_read_b32 v62, v49 offset:16
    v_add_f32_dpp v40, v33, v32 quad_perm:[1,1,3,3] row_mask:0xf bank_mask:0xf
    v_add_f32_dpp v41, v35, v34 quad_perm:[1,1,3,3] row_mask:0xf bank_mask:0xf
    v_mfma_f32_16x16x32_bf16 v[36:39], v[16:19], v[208:211], 0
    v_mfma_f32_16x16x32_bf16 v[36:39], v[20:23], v[212:215], v[36:39]
    v_mfma_f32_16x16x32_bf16 v[36:39], v[24:27], v[216:219], v[36:39]
    v_mfma_f32_16x16x32_bf16 v[36:39], v[28:31], v[220:223], v[36:39]
    s_waitcnt vmcnt(6)
    s_bitcmp1_b32 s79, 4
    s_cbranch_scc0 L_w21
    s_waitcnt vmcnt(4)
L_w21:
    buffer_load_dwordx4 v[208:211], v1, s[32:35], s61 offen offset:0 nt
    s_waitcnt vmcnt(6)
    s_bitcmp1_b32 s79, 5
    s_cbranch_scc0 L_w22
    s_waitcnt vmcnt(4)
L_w22:
    buffer_load_dwordx4 v[212:215], v1, s[32:35], s61 offen offset:128 nt
    v_add_u32 v48, 8, v48
    ds_write_b32 v49, v48
    s_waitcnt vmcnt(6)
    s_bitcmp1_b32 s79, 6
    s_cbranch_scc0 L_w23
    s_waitcnt vmcnt(4)
L_w23:
    buffer_load_dwordx4 v[216:219], v1, s[32:35], s61 offen offset:256 nt
    s_waitcnt vmcnt(6)
    s_bitcmp1_b32 s79, 7
    s_cbranch_scc0 L_w24
    s_waitcnt vmcnt(4)
L_w24:
    buffer_load_dwordx4 v[220:223], v1, s[32:35], s61 offen offset:384 nt
    v_add_u32 v48, 8, v48
    ds_write_b32 v49, v48
    v_add_f32_dpp v42, v37, v36 quad_perm:[1,1,3,3] row_mask:0xf bank_mask:0xf
    v_add_f32_dpp v43, v39, v38 quad_perm:[1,1,3,3] row_mask:0xf bank_mask:0xf
    s_mov_b64 exec, 0x5555
    ds_write_b128 v4, v[40:43] offset:256
    s_mov_b64 exec, -1
    s_add_u32 s60, s60, 0x10000
    s_add_u32 s61, s60, 4096
    v_mfma_f32_16x16x32_bf16 v[32:35], v[16:19], v[224:227], 0
    v_mfma_f32_16x16x32_bf16 v[32:35], v[20:23], v[228:231], v[32:35]
    v_mfma_f32_16x16x32_bf16 v[32:35], v[24:27], v[232:235], v[32:35]
    v_mfma_f32_16x16x32_bf16 v[32:35], v[28:31], v[236:239], v[32:35]
    s_waitcnt vmcnt(6)
    s_bitcmp1_b32 s79, 8
    s_cbranch_scc0 L_w25
    s_waitcnt vmcnt(4)
L_w25:
    buffer_load_dwordx4 v[224:227], v1, s[32:35], s60 offen offset:0 nt
    s_waitcnt vmcnt(6)
    s_bitcmp1_b32 s79, 9
    s_cbranch_scc0 L_w26
    s_waitcnt vmcnt(4)
L_w26:
    buffer_load_dwordx4 v[228:231], v1, s[32:35], s60 offen offset:128 nt
    v_add_u32 v48, 8, v48
    ds_write_b32 v49, v48
    s_waitcnt vmcnt(6)
    s_bitcmp1_b32 s79, 10
    s_cbranch_scc0 L_w27
    s_waitcnt vmcnt(4)
L_w27:
    buffer_load_dwordx4 v[232:235], v1, s[32:35], s60 offen offset:256 nt
    s_waitcnt vmcnt(6)
    s_bitcmp1_b32 s79, 11
    s_cbranch_scc0 L_w28
    s_waitcnt vmcnt(4)
L_w28:
    buffer_load_dwordx4 v[236:239], v1, s[32:35], s60 offen offset:384 nt
    s_waitcnt lgkmcnt(0)
    v_readfirstlane_b32 s79, v62
    v_add_u32 v46, 32, v46
    v_mov_b32 v48, v46
    ds_write_b32 v49, v46
    ds_read_b32 v62, v49 offset:16
    v_add_f32_dpp v40, v33, v32 quad_perm:[1,1,3,3] row_mask:0xf bank_mask:0xf
    v_add_f32_dpp v41, v35, v34 quad_perm:[1,1,3,3] row_mask:0xf bank_mask:0xf
    v_mfma_f32_16x16x32_bf16 v[36:39], v[16:19], v[240:243], 0
    v_mfma_f32_16x16x32_bf16 v[36:39], v[20:23], v[244:247], v[36:39]
    v_mfma_f32_16x16x32_bf16 v[36:39], v[24:27], v[248:251], v[36:39]
    v_mfma_f32_16x16x32_bf16 v[36:39], v[28:31], v[252:255], v[36:39]
    s_waitcnt vmcnt(6)
    s_bitcmp1_b32 s79, 12
    s_cbranch_scc0 L_w29
    s_waitcnt vmcnt(4)
L_w29:
    buffer_load_dwordx4 v[240:243], v1, s[32:35], s61 offen offset:0 nt
    s_waitcnt vmcnt(6)
    s_bitcmp1_b32 s79, 13
    s_cbranch_scc0 L_w30
    s_waitcnt vmcnt(4)
L_w30:
    buffer_load_dwordx4 v[244:247], v1, s[32:35], s61 offen offset:128 nt
    v_add_u32 v48, 8, v48
    ds_write_b32 v49, v48
    s_waitcnt vmcnt(6)
    s_bitcmp1_b32 s79, 14
    s_cbranch_scc0 L_w31
    s_waitcnt vmcnt(4)
L_w31:
    buffer_load_dwordx4 v[248:251], v1, s[32:35], s61 offen offset:256 nt
    s_waitcnt vmcnt(6)
    s_bitcmp1_b32 s79, 15
    s_cbranch_scc0 L_w32
    s_waitcnt vmcnt(4)
L_w32:
    buffer_load_dwordx4 v[252:255], v1, s[32:35], s61 offen offset:384 nt
    v_add_u32 v48, 8, v48
    ds_write_b32 v49, v48
    v_add_f32_dpp v42, v37, v36 quad_perm:[1,1,3,3] row_mask:0xf bank_mask:0xf
    v_add_f32_dpp v43, v39, v38 quad_perm:[1,1,3,3] row_mask:0xf bank_mask:0xf
    s_mov_b64 exec, 0x5555
    ds_write_b128 v4, v[40:43] offset:384
    s_mov_b64 exec, -1
    s_add_u32 s60, s60, 0x10000
    v_add_u32 v4, 512, v4
    s_add_u32 s59, s59, 1
    s_cmp_lt_u32 s59, 7
    s_cbranch_scc1 L_kloop
    s_mov_b32 s60, s66
    s_add_u32 s61, s60, 4096
    s_add_u32 s68, s60, 0x10000
    s_add_u32 s69, s60, 0x11000
    v_mfma_f32_16x16x32_bf16 v[32:35], v[16:19], v[128:131], 0
    v_mfma_f32_16x16x32_bf16 v[32:35], v[20:23], v[132:135], v[32:35]
    v_mfma_f32_16x16x32_bf16 v[32:35], v[24:27], v[136:139], v[32:35]
    v_mfma_f32_16x16x32_bf16 v[32:35], v[28:31], v[140:143], v[32:35]
    s_waitcnt vmcnt(5)
    buffer_load_dwordx4 v[64:67], v2, s[40:43], s60 offen offset:0 nt
    s_nop 5
    v_add_f32_dpp v40, v33, v32 quad_perm:[1,1,3,3] row_mask:0xf bank_mask:0xf
    v_add_f32_dpp v41, v35, v34 quad_perm:[1,1,3,3] row_mask:0xf bank_mask:0xf
    v_mfma_f32_16x16x32_bf16 v[36:39], v[16:19], v[144:147], 0
    v_mfma_f32_16x16x32_bf16 v[36:39], v[20:23], v[148:151], v[36:39]
    v_mfma_f32_16x16x32_bf16 v[36:39], v[24:27], v[152:155], v[36:39]
    v_mfma_f32_16x16x32_bf16 v[36:39], v[28:31], v[156:159], v[36:39]
    s_waitcnt vmcnt(5)
    buffer_load_dwordx4 v[68:71], v2, s[40:43], s60 offen offset:1024 nt
    s_nop 5
    v_add_f32_dpp v42, v37, v36 quad_perm:[1,1,3,3] row_mask:0xf bank_mask:0xf
    v_add_f32_dpp v43, v39, v38 quad_perm:[1,1,3,3] row_mask:0xf bank_mask:0xf
    s_mov_b64 exec, 0x5555
    ds_write_b128 v4, v[40:43] offset:0
    s_mov_b64 exec, -1
    v_mfma_f32_16x16x32_bf16 v[32:35], v[16:19], v[160:163], 0
    v_mfma_f32_16x16x32_bf16 v[32:35], v[20:23], v[164:167], v[32:35]
    v_mfma_f32_16x16x32_bf16 v[32:35], v[24:27], v[168:171], v[32:35]
    v_mfma_f32_16x16x32_bf16 v[32:35], v[28:31], v[172:175], v[32:35]
    s_waitcnt vmcnt(5)
    buffer_load_dwordx4 v[72:75], v2, s[40:43], s60 offen offset:2048 nt
    s_waitcnt lgkmcnt(0)
    v_readfirstlane_b32 s79, v62
    v_add_u32 v46, 32, v46
    v_mov_b32 v48, v46
    ds_write_b32 v49, v46
    ds_read_b32 v62, v49 offset:16
    s_nop 5
    v_add_f32_dpp v40, v33, v32 quad_perm:[1,1,3,3] row_mask:0xf bank_mask:0xf
    v_add_f32_dpp v41, v35, v34 quad_perm:[1,1,3,3] row_mask:0xf bank_mask:0xf
    v_mfma_f32_16x16x32_bf16 v[36:39], v[16:19], v[176:179], 0
    v_mfma_f32_16x16x32_bf16 v[36:39], v[20:23], v[180:183], v[36:39]
    v_mfma_f32_16x16x32_bf16 v[36:39], v[24:27], v[184:187], v[36:39]
    v_mfma_f32_16x16x32_bf16 v[36:39], v[28:31], v[188:191], v[36:39]
    s_waitcnt vmcnt(5)
    buffer_load_dwordx4 v[76:79], v2, s[40:43], s60 offen offset:3072 nt
    s_nop 5
    v_add_f32_dpp v42, v37, v36 quad_perm:[1,1,3,3] row_mask:0xf bank_mask:0xf
    v_add_f32_dpp v43, v39, v38 quad_perm:[1,1,3,3] row_mask:0xf bank_mask:0xf
    s_mov_b64 exec, 0x5555
    ds_write_b128 v4, v[40:43] offset:128
    s_mov_b64 exec, -1
    v_mfma_f32_16x16x32_bf16 v[32:35], v[16:19], v[192:195], 0
    v_mfma_f32_16x16x32_bf16 v[32:35], v[20:23], v[196:199], v[32:35]
    v_mfma_f32_16x16x32_bf16 v[32:35], v[24:27], v[200:203], v[32:35]
    v_mfma_f32_16x16x32_bf16 v[32:35], v[28:31], v[204:207], v[32:35]
    s_waitcnt vmcnt(5)
    buffer_load_dwordx4 v[80:83], v2, s[40:43], s61 offen offset:0 nt
    s_nop 5
    v_add_f32_dpp v40, v33, v32 quad_perm:[1,1,3,3] row_mask:0xf bank_mask:0xf
    v_add_f32_dpp v41, v35, v34 quad_perm:[1,1,3,3] row_mask:0xf bank_mask:0xf
    v_mfma_f32_16x16x32_bf16 v[36:39], v[16:19], v[208:211], 0
    v_mfma_f32_16x16x32_bf16 v[36:39], v[20:23], v[212:215], v[36:39]
    v_mfma_f32_16x16x32_bf16 v[36:39], v[24:27], v[216:219], v[36:39]
    v_mfma_f32_16x16x32_bf16 v[36:39], v[28:31], v[220:223], v[36:39]
    s_waitcnt vmcnt(5)
    buffer_load_dwordx4 v[84:87], v2, s[40:43], s61 offen offset:1024 nt
    s_waitcnt vmcnt(6)
    buffer_load_dwordx4 v[88:91], v2, s[40:43], s61 offen offset:2048 nt
    buffer_load_dwordx4 v[92:95], v2, s[40:43], s61 offen offset:3072 nt
    buffer_load_dwordx4 v[96:99], v2, s[40:43], s68 offen offset:0 nt
    buffer_load_dwordx4 v[100:103], v2, s[40:43], s68 offen offset:1024 nt
    buffer_load_dwordx4 v[104:107], v2, s[40:43], s68 offen offset:2048 nt
    buffer_load_dwordx4 v[108:111], v2, s[40:43], s68 offen offset:3072 nt
    buffer_load_dwordx4 v[112:115], v2, s[40:43], s69 offen offset:0 nt
    buffer_load_dwordx4 v[116:119], v2, s[40:43], s69 offen offset:1024 nt
    buffer_load_dwordx4 v[120:123], v2, s[40:43], s69 offen offset:2048 nt
    buffer_load_dwordx4 v[124:127], v2, s[40:43], s69 offen offset:3072 nt
    v_add_f32_dpp v42, v37, v36 quad_perm:[1,1,3,3] row_mask:0xf bank_mask:0xf
    v_add_f32_dpp v43, v39, v38 quad_perm:[1,1,3,3] row_mask:0xf bank_mask:0xf
    s_mov_b64 exec, 0x5555
    ds_write_b128 v4, v[40:43] offset:256
    s_mov_b64 exec, -1
    v_mfma_f32_16x16x32_bf16 v[32:35], v[16:19], v[224:227], 0
    v_mfma_f32_16x16x32_bf16 v[32:35], v[20:23], v[228:231], v[32:35]
    v_mfma_f32_16x16x32_bf16 v[32:35], v[24:27], v[232:235], v[32:35]
    v_mfma_f32_16x16x32_bf16 v[32:35], v[28:31], v[236:239], v[32:35]
    s_nop 7
    v_add_f32_dpp v40, v33, v32 quad_perm:[1,1,3,3] row_mask:0xf bank_mask:0xf
    v_add_f32_dpp v41, v35, v34 quad_perm:[1,1,3,3] row_mask:0xf bank_mask:0xf
    v_mfma_f32_16x16x32_bf16 v[36:39], v[16:19], v[240:243], 0
    v_mfma_f32_16x16x32_bf16 v[36:39], v[20:23], v[244:247], v[36:39]
    v_mfma_f32_16x16x32_bf16 v[36:39], v[24:27], v[248:251], v[36:39]
    v_mfma_f32_16x16x32_bf16 v[36:39], v[28:31], v[252:255], v[36:39]
    s_nop 7
    v_add_f32_dpp v42, v37, v36 quad_perm:[1,1,3,3] row_mask:0xf bank_mask:0xf
    v_add_f32_dpp v43, v39, v38 quad_perm:[1,1,3,3] row_mask:0xf bank_mask:0xf
    s_mov_b64 exec, 0x5555
    ds_write_b128 v4, v[40:43] offset:384
    s_mov_b64 exec, -1
    s_add_u32 s60, s60, 0x20000
    s_waitcnt lgkmcnt(0)
    ds_read_b128 v[128:131], v14 offset:0
    ds_read_b128 v[132:135], v14 offset:1024
    ds_read_b128 v[136:139], v14 offset:2048
    ds_read_b128 v[140:143], v14 offset:3072
    s_mov_b32 s63, 0x3db8aa3b
    s_waitcnt lgkmcnt(0)
    v_readfirstlane_b32 s79, v62
    v_add_u32 v46, 32, v46
    v_mov_b32 v48, v46
    ds_write_b32 v49, v46
    ds_read_b32 v62, v49 offset:16
    v_cvt_pk_bf16_f32 v129, v128, v129
    v_lshlrev_b32 v128, 16, v129
    v_and_b32 v129, s62, v129
    v_cvt_pk_bf16_f32 v131, v130, v131
    v_lshlrev_b32 v130, 16, v131
    v_and_b32 v131, s62, v131
    v_cvt_pk_bf16_f32 v133, v132, v133
    v_lshlrev_b32 v132, 16, v133
    v_and_b32 v133, s62, v133
    v_cvt_pk_bf16_f32 v135, v134, v135
    v_lshlrev_b32 v134, 16, v135
    v_and_b32 v135, s62, v135
    v_cvt_pk_bf16_f32 v137, v136, v137
    v_lshlrev_b32 v136, 16, v137
    v_and_b32 v137, s62, v137
    v_cvt_pk_bf16_f32 v139, v138, v139
    v_lshlrev_b32 v138, 16, v139
    v_and_b32 v139, s62, v139
    v_cvt_pk_bf16_f32 v141, v140, v141
    v_lshlrev_b32 v140, 16, v141
    v_and_b32 v141, s62, v141
    v_cvt_pk_bf16_f32 v143, v142, v143
    v_lshlrev_b32 v142, 16, v143
    v_and_b32 v143, s62, v143
    v_max3_f32 v148, v128, v130, v132
    v_max3_f32 v148, v148, v134, v136
    v_max3_f32 v148, v148, v138, v140
    v_max_f32 v148, v148, v142
    v_max3_f32 v150, v129, v131, v133
    v_max3_f32 v150, v150, v135, v137
    v_max3_f32 v150, v150, v139, v141
    v_max_f32 v150, v150, v143
    s_nop 1
    v_max_f32_dpp v148, v148, v148 row_ror:8 row_mask:0xf bank_mask:0xf
    v_max_f32_dpp v150, v150, v150 row_ror:8 row_mask:0xf bank_mask:0xf
    s_nop 0
    v_max_f32_dpp v148, v148, v148 row_ror:4 row_mask:0xf bank_mask:0xf
    v_max_f32_dpp v150, v150, v150 row_ror:4 row_mask:0xf bank_mask:0xf
    s_nop 0
    v_max_f32_dpp v148, v148, v148 row_ror:2 row_mask:0xf bank_mask:0xf
    v_max_f32_dpp v150, v150, v150 row_ror:2 row_mask:0xf bank_mask:0xf
    s_nop 0
    v_max_f32_dpp v148, v148, v148 row_ror:1 row_mask:0xf bank_mask:0xf
    v_max_f32_dpp v150, v150, v150 row_ror:1 row_mask:0xf bank_mask:0xf
    v_mov_b32 v152, v148
    v_mov_b32 v153, v150
    s_nop 1
    v_permlane16_swap_b32 v148, v152
    v_permlane16_swap_b32 v150, v153
    s_nop 0
    v_max_f32 v148, v148, v152
    v_max_f32 v150, v150, v153
    v_mov_b32 v152, v148
    v_mov_b32 v153, v150
    s_nop 1
    v_permlane32_swap_b32 v148, v152
    v_permlane32_swap_b32 v150, v153
    s_nop 0
    v_max_f32 v148, v148, v152
    v_max_f32 v150, v150, v153
    v_mul_f32 v148, s63, v148
    v_mul_f32 v150, s63, v150
    v_fma_f32 v128, v128, s63, -v148
    v_fma_f32 v129, v129, s63, -v150
    v_fma_f32 v130, v130, s63, -v148
    v_fma_f32 v131, v131, s63, -v150
    v_fma_f32 v132, v132, s63, -v148
    v_fma_f32 v133, v133, s63, -v150
    v_fma_f32 v134, v134, s63, -v148
    v_fma_f32 v135, v135, s63, -v150
    v_fma_f32 v136, v136, s63, -v148
    v_fma_f32 v137, v137, s63, -v150
    v_fma_f32 v138, v138, s63, -v148
    v_fma_f32 v139, v139, s63, -v150
    v_fma_f32 v140, v140, s63, -v148
    v_fma_f32 v141, v141, s63, -v150
    v_fma_f32 v142, v142, s63, -v148
    v_fma_f32 v143, v143, s63, -v150
    v_exp_f32 v128, v128
    v_exp_f32 v129, v129
    v_exp_f32 v130, v130
    v_exp_f32 v131, v131
    v_exp_f32 v132, v132
    v_exp_f32 v133, v133
    v_exp_f32 v134, v134
    v_exp_f32 v135, v135
    v_exp_f32 v136, v136
    v_exp_f32 v137, v137
    v_exp_f32 v138, v138
    v_exp_f32 v139, v139
    v_exp_f32 v140, v140
    v_exp_f32 v141, v141
    v_exp_f32 v142, v142
    v_exp_f32 v143, v143
    s_nop 0
    ds_write_b128 v14, v[128:131] offset:0
    ds_write_b128 v14, v[132:135] offset:1024
    ds_write_b128 v14, v[136:139] offset:2048
    ds_write_b128 v14, v[140:143] offset:3072
    v_add_f32 v149, v128, v130
    v_add_f32 v149, v149, v132
    v_add_f32 v149, v149, v134
    v_add_f32 v149, v149, v136
    v_add_f32 v149, v149, v138
    v_add_f32 v149, v149, v140
    v_add_f32 v149, v149, v142
    v_add_f32 v151, v129, v131
    v_add_f32 v151, v151, v133
    v_add_f32 v151, v151, v135
    v_add_f32 v151, v151, v137
    v_add_f32 v151, v151, v139
    v_add_f32 v151, v151, v141
    v_add_f32 v151, v151, v143
    s_waitcnt lgkmcnt(0)
    ds_read_b128 v[160:163], v5 offset:0
    ds_read_b128 v[164:167], v5 offset:32
    ds_read_b128 v[168:171], v5 offset:64
    ds_read_b128 v[172:175], v5 offset:96
    s_nop 1
    v_add_f32_dpp v149, v149, v149 row_ror:8 row_mask:0xf bank_mask:0xf
    v_add_f32_dpp v151, v151, v151 row_ror:8 row_mask:0xf bank_mask:0xf
    s_nop 0
    v_add_f32_dpp v149, v149, v149 row_ror:4 row_mask:0xf bank_mask:0xf
    v_add_f32_dpp v151, v151, v151 row_ror:4 row_mask:0xf bank_mask:0xf
    s_nop 0
    v_add_f32_dpp v149, v149, v149 row_ror:2 row_mask:0xf bank_mask:0xf
    v_add_f32_dpp v151, v151, v151 row_ror:2 row_mask:0xf bank_mask:0xf
    s_nop 0
    v_add_f32_dpp v149, v149, v149 row_ror:1 row_mask:0xf bank_mask:0xf
    v_add_f32_dpp v151, v151, v151 row_ror:1 row_mask:0xf bank_mask:0xf
    v_mov_b32 v152, v149
    v_mov_b32 v153, v151
    s_nop 1
    v_permlane16_swap_b32 v149, v152
    v_permlane16_swap_b32 v151, v153
    s_nop 0
    v_add_f32 v149, v149, v152
    v_add_f32 v151, v151, v153
    v_mov_b32 v152, v149
    v_mov_b32 v153, v151
    s_nop 1
    v_permlane32_swap_b32 v149, v152
    v_permlane32_swap_b32 v151, v153
    s_nop 0
    v_add_f32 v149, v149, v152
    v_add_f32 v151, v151, v153
    s_mov_b64 exec, 1
    ds_write_b128 v15, v[148:151]
    s_mov_b64 exec, -1
    v_mov_b32 v16, 0
    v_mov_b32 v17, 0
    v_mov_b32 v18, 0
    v_mov_b32 v19, 0
    v_mov_b32 v20, 0
    v_mov_b32 v21, 0
    v_mov_b32 v22, 0
    v_mov_b32 v23, 0
    v_mov_b32 v24, 0
    v_mov_b32 v25, 0
    v_mov_b32 v26, 0
    v_mov_b32 v27, 0
    v_mov_b32 v28, 0
    v_mov_b32 v29, 0
    v_mov_b32 v30, 0
    v_mov_b32 v31, 0
    s_mov_b32 s59, 0
    s_waitcnt vmcnt(15)
L_vloop:
    s_add_u32 s61, s60, 4096
    s_waitcnt lgkmcnt(0)
    v_readfirstlane_b32 s79, v62
    v_add_u32 v46, 32, v46
    v_mov_b32 v48, v46
    ds_write_b32 v49, v46
    ds_read_b32 v62, v49 offset:16
    ds_read_b128 v[176:179], v5 offset:128
    ds_read_b128 v[180:183], v5 offset:160
    ds_read_b128 v[184:187], v5 offset:192
    ds_read_b128 v[188:191], v5 offset:224
    v_lshlrev_b32 v52, 16, v64
    v_and_b32 v53, s62, v64
    v_lshlrev_b32 v54, 16, v65
    v_and_b32 v55, s62, v65
    v_lshlrev_b32 v56, 16, v66
    v_and_b32 v57, s62, v66
    v_lshlrev_b32 v58, 16, v67
    v_and_b32 v59, s62, v67
    v_pk_fma_f32 v[16:17], v[52:53], v[160:161], v[16:17] op_sel:[0,0,0] op_sel_hi:[1,0,1]
    v_pk_fma_f32 v[18:19], v[54:55], v[160:161], v[18:19] op_sel:[0,0,0] op_sel_hi:[1,0,1]
    v_pk_fma_f32 v[20:21], v[56:57], v[160:161], v[20:21] op_sel:[0,0,0] op_sel_hi:[1,0,1]
    v_pk_fma_f32 v[22:23], v[58:59], v[160:161], v[22:23] op_sel:[0,0,0] op_sel_hi:[1,0,1]
    v_pk_fma_f32 v[24:25], v[52:53], v[160:161], v[24:25] op_sel:[0,1,0] op_sel_hi:[1,1,1]
    v_pk_fma_f32 v[26:27], v[54:55], v[160:161], v[26:27] op_sel:[0,1,0] op_sel_hi:[1,1,1]
    v_pk_fma_f32 v[28:29], v[56:57], v[160:161], v[28:29] op_sel:[0,1,0] op_sel_hi:[1,1,1]
    v_pk_fma_f32 v[30:31], v[58:59], v[160:161], v[30:31] op_sel:[0,1,0] op_sel_hi:[1,1,1]
    s_waitcnt vmcnt(6)
    s_bitcmp1_b32 s79, 0
    s_cbranch_scc0 L_w33
    s_waitcnt vmcnt(4)
L_w33:
    buffer_load_dwordx4 v[64:67], v2, s[40:43], s60 offen offset:0 nt
    v_lshlrev_b32 v52, 16, v68
    v_and_b32 v53, s62, v68
    v_lshlrev_b32 v54, 16, v69
    v_and_b32 v55, s62, v69
    v_lshlrev_b32 v56, 16, v70
    v_and_b32 v57, s62, v70
    v_lshlrev_b32 v58, 16, v71
    v_and_b32 v59, s62, v71
    v_pk_fma_f32 v[16:17], v[52:53], v[164:165], v[16:17] op_sel:[0,0,0] op_sel_hi:[1,0,1]
    v_pk_fma_f32 v[18:19], v[54:55], v[164:165], v[18:19] op_sel:[0,0,0] op_sel_hi:[1,0,1]
    v_pk_fma_f32 v[20:21], v[56:57], v[164:165], v[20:21] op_sel:[0,0,0] op_sel_hi:[1,0,1]
    v_pk_fma_f32 v[22:23], v[58:59], v[164:165], v[22:23] op_sel:[0,0,0] op_sel_hi:[1,0,1]
    v_pk_fma_f32 v[24:25], v[52:53], v[164:165], v[24:25] op_sel:[0,1,0] op_sel_hi:[1,1,1]
    v_pk_fma_f32 v[26:27], v[54:55], v[164:165], v[26:27] op_sel:[0,1,0] op_sel_hi:[1,1,1]
    v_pk_fma_f32 v[28:29], v[56:57], v[164:165], v[28:29] op_sel:[0,1,0] op_sel_hi:[1,1,1]
    v_pk_fma_f32 v[30:31], v[58:59], v[164:165], v[30:31] op_sel:[0,1,0] op_sel_hi:[1,1,1]
    s_waitcnt vmcnt(6)
    s_bitcmp1_b32 s79, 1
    s_cbranch_scc0 L_w34
    s_waitcnt vmcnt(4)
L_w34:
    buffer_load_dwordx4 v[68:71], v2, s[40:43], s60 offen offset:1024 nt
    v_add_u32 v48, 8, v48
    ds_write_b32 v49, v48
    v_lshlrev_b32 v52, 16, v72
    v_and_b32 v53, s62, v72
    v_lshlrev_b32 v54, 16, v73
    v_and_b32 v55, s62, v73
    v_lshlrev_b32 v56, 16, v74
    v_and_b32 v57, s62, v74
    v_lshlrev_b32 v58, 16, v75
    v_and_b32 v59, s62, v75
    v_pk_fma_f32 v[16:17], v[52:53], v[168:169], v[16:17] op_sel:[0,0,0] op_sel_hi:[1,0,1]
    v_pk_fma_f32 v[18:19], v[54:55], v[168:169], v[18:19] op_sel:[0,0,0] op_sel_hi:[1,0,1]
    v_pk_fma_f32 v[20:21], v[56:57], v[168:169], v[20:21] op_sel:[0,0,0] op_sel_hi:[1,0,1]
    v_pk_fma_f32 v[22:23], v[58:59], v[168:169], v[22:23] op_sel:[0,0,0] op_sel_hi:[1,0,1]
    v_pk_fma_f32 v[24:25], v[52:53], v[168:169], v[24:25] op_sel:[0,1,0] op_sel_hi:[1,1,1]
    v_pk_fma_f32 v[26:27], v[54:55], v[168:169], v[26:27] op_sel:[0,1,0] op_sel_hi:[1,1,1]
    v_pk_fma_f32 v[28:29], v[56:57], v[168:169], v[28:29] op_sel:[0,1,0] op_sel_hi:[1,1,1]
    v_pk_fma_f32 v[30:31], v[58:59], v[168:169], v[30:31] op_sel:[0,1,0] op_sel_hi:[1,1,1]
    s_waitcnt vmcnt(6)
    s_bitcmp1_b32 s79, 2
    s_cbranch_scc0 L_w35
    s_waitcnt vmcnt(4)
L_w35:
    buffer_load_dwordx4 v[72:75], v2, s[40:43], s60 offen offset:2048 nt
    v_lshlrev_b32 v52, 16, v76
    v_and_b32 v53, s62, v76
    v_lshlrev_b32 v54, 16, v77
    v_and_b32 v55, s62, v77
    v_lshlrev_b32 v56, 16, v78
    v_and_b32 v57, s62, v78
    v_lshlrev_b32 v58, 16, v79
    v_and_b32 v59, s62, v79
    v_pk_fma_f32 v[16:17], v[52:53], v[172:173], v[16:17] op_sel:[0,0,0] op_sel_hi:[1,0,1]
    v_pk_fma_f32 v[18:19], v[54:55], v[172:173], v[18:19] op_sel:[0,0,0] op_sel_hi:[1,0,1]
    v_pk_fma_f32 v[20:21], v[56:57], v[172:173], v[20:21] op_sel:[0,0,0] op_sel_hi:[1,0,1]
    v_pk_fma_f32 v[22:23], v[58:59], v[172:173], v[22:23] op_sel:[0,0,0] op_sel_hi:[1,0,1]
    v_pk_fma_f32 v[24:25], v[52:53], v[172:173], v[24:25] op_sel:[0,1,0] op_sel_hi:[1,1,1]
    v_pk_fma_f32 v[26:27], v[54:55], v[172:173], v[26:27] op_sel:[0,1,0] op_sel_hi:[1,1,1]
    v_pk_fma_f32 v[28:29], v[56:57], v[172:173], v[28:29] op_sel:[0,1,0] op_sel_hi:[1,1,1]
    v_pk_fma_f32 v[30:31], v[58:59], v[172:173], v[30:31] op_sel:[0,1,0] op_sel_hi:[1,1,1]
    s_waitcnt vmcnt(6)
    s_bitcmp1_b32 s79, 3
    s_cbranch_scc0 L_w36
    s_waitcnt vmcnt(4)
L_w36:
    buffer_load_dwordx4 v[76:79], v2, s[40:43], s60 offen offset:3072 nt
    v_add_u32 v48, 8, v48
    ds_write_b32 v49, v48
    v_lshlrev_b32 v52, 16, v80
    v_and_b32 v53, s62, v80
    v_lshlrev_b32 v54, 16, v81
    v_and_b32 v55, s62, v81
    v_lshlrev_b32 v56, 16, v82
    v_and_b32 v57, s62, v82
    v_lshlrev_b32 v58, 16, v83
    v_and_b32 v59, s62, v83
    v_pk_fma_f32 v[16:17], v[52:53], v[162:163], v[16:17] op_sel:[0,0,0] op_sel_hi:[1,0,1]
    v_pk_fma_f32 v[18:19], v[54:55], v[162:163], v[18:19] op_sel:[0,0,0] op_sel_hi:[1,0,1]
    v_pk_fma_f32 v[20:21], v[56:57], v[162:163], v[20:21] op_sel:[0,0,0] op_sel_hi:[1,0,1]
    v_pk_fma_f32 v[22:23], v[58:59], v[162:163], v[22:23] op_sel:[0,0,0] op_sel_hi:[1,0,1]
    v_pk_fma_f32 v[24:25], v[52:53], v[162:163], v[24:25] op_sel:[0,1,0] op_sel_hi:[1,1,1]
    v_pk_fma_f32 v[26:27], v[54:55], v[162:163], v[26:27] op_sel:[0,1,0] op_sel_hi:[1,1,1]
    v_pk_fma_f32 v[28:29], v[56:57], v[162:163], v[28:29] op_sel:[0,1,0] op_sel_hi:[1,1,1]
    v_pk_fma_f32 v[30:31], v[58:59], v[162:163], v[30:31] op_sel:[0,1,0] op_sel_hi:[1,1,1]
    s_waitcnt vmcnt(6)
    s_bitcmp1_b32 s79, 4
    s_cbranch_scc0 L_w37
    s_waitcnt vmcnt(4)
L_w37:
    buffer_load_dwordx4 v[80:83], v2, s[40:43], s61 offen offset:0 nt
    v_lshlrev_b32 v52, 16, v84
    v_and_b32 v53, s62, v84
    v_lshlrev_b32 v54, 16, v85
    v_and_b32 v55, s62, v85
    v_lshlrev_b32 v56, 16, v86
    v_and_b32 v57, s62, v86
    v_lshlrev_b32 v58, 16, v87
    v_and_b32 v59, s62, v87
    v_pk_fma_f32 v[16:17], v[52:53], v[166:167], v[16:17] op_sel:[0,0,0] op_sel_hi:[1,0,1]
    v_pk_fma_f32 v[18:19], v[54:55], v[166:167], v[18:19] op_sel:[0,0,0] op_sel_hi:[1,0,1]
    v_pk_fma_f32 v[20:21], v[56:57], v[166:167], v[20:21] op_sel:[0,0,0] op_sel_hi:[1,0,1]
    v_pk_fma_f32 v[22:23], v[58:59], v[166:167], v[22:23] op_sel:[0,0,0] op_sel_hi:[1,0,1]
    v_pk_fma_f32 v[24:25], v[52:53], v[166:167], v[24:25] op_sel:[0,1,0] op_sel_hi:[1,1,1]
    v_pk_fma_f32 v[26:27], v[54:55], v[166:167], v[26:27] op_sel:[0,1,0] op_sel_hi:[1,1,1]
    v_pk_fma_f32 v[28:29], v[56:57], v[166:167], v[28:29] op_sel:[0,1,0] op_sel_hi:[1,1,1]
    v_pk_fma_f32 v[30:31], v[58:59], v[166:167], v[30:31] op_sel:[0,1,0] op_sel_hi:[1,1,1]
    s_waitcnt vmcnt(6)
    s_bitcmp1_b32 s79, 5
    s_cbranch_scc0 L_w38
    s_waitcnt vmcnt(4)
L_w38:
    buffer_load_dwordx4 v[84:87], v2, s[40:43], s61 offen offset:1024 nt
    v_add_u32 v48, 8, v48
    ds_write_b32 v49, v48
    v_lshlrev_b32 v52, 16, v88
    v_and_b32 v53, s62, v88
    v_lshlrev_b32 v54, 16, v89
    v_and_b32 v55, s62, v89
    v_lshlrev_b32 v56, 16, v90
    v_and_b32 v57, s62, v90
    v_lshlrev_b32 v58, 16, v91
    v_and_b32 v59, s62, v91
    v_pk_fma_f32 v[16:17], v[52:53], v[170:171], v[16:17] op_sel:[0,0,0] op_sel_hi:[1,0,1]
    v_pk_fma_f32 v[18:19], v[54:55], v[170:171], v[18:19] op_sel:[0,0,0] op_sel_hi:[1,0,1]
    v_pk_fma_f32 v[20:21], v[56:57], v[170:171], v[20:21] op_sel:[0,0,0] op_sel_hi:[1,0,1]
    v_pk_fma_f32 v[22:23], v[58:59], v[170:171], v[22:23] op_sel:[0,0,0] op_sel_hi:[1,0,1]
    v_pk_fma_f32 v[24:25], v[52:53], v[170:171], v[24:25] op_sel:[0,1,0] op_sel_hi:[1,1,1]
    v_pk_fma_f32 v[26:27], v[54:55], v[170:171], v[26:27] op_sel:[0,1,0] op_sel_hi:[1,1,1]
    v_pk_fma_f32 v[28:29], v[56:57], v[170:171], v[28:29] op_sel:[0,1,0] op_sel_hi:[1,1,1]
    v_pk_fma_f32 v[30:31], v[58:59], v[170:171], v[30:31] op_sel:[0,1,0] op_sel_hi:[1,1,1]
    s_waitcnt vmcnt(6)
    s_bitcmp1_b32 s79, 6
    s_cbranch_scc0 L_w39
    s_waitcnt vmcnt(4)
L_w39:
    buffer_load_dwordx4 v[88:91], v2, s[40:43], s61 offen offset:2048 nt
    v_lshlrev_b32 v52, 16, v92
    v_and_b32 v53, s62, v92
    v_lshlrev_b32 v54, 16, v93
    v_and_b32 v55, s62, v93
    v_lshlrev_b32 v56, 16, v94
    v_and_b32 v57, s62, v94
    v_lshlrev_b32 v58, 16, v95
    v_and_b32 v59, s62, v95
    v_pk_fma_f32 v[16:17], v[52:53], v[174:175], v[16:17] op_sel:[0,0,0] op_sel_hi:[1,0,1]
    v_pk_fma_f32 v[18:19], v[54:55], v[174:175], v[18:19] op_sel:[0,0,0] op_sel_hi:[1,0,1]
    v_pk_fma_f32 v[20:21], v[56:57], v[174:175], v[20:21] op_sel:[0,0,0] op_sel_hi:[1,0,1]
    v_pk_fma_f32 v[22:23], v[58:59], v[174:175], v[22:23] op_sel:[0,0,0] op_sel_hi:[1,0,1]
    v_pk_fma_f32 v[24:25], v[52:53], v[174:175], v[24:25] op_sel:[0,1,0] op_sel_hi:[1,1,1]
    v_pk_fma_f32 v[26:27], v[54:55], v[174:175], v[26:27] op_sel:[0,1,0] op_sel_hi:[1,1,1]
    v_pk_fma_f32 v[28:29], v[56:57], v[174:175], v[28:29] op_sel:[0,1,0] op_sel_hi:[1,1,1]
    v_pk_fma_f32 v[30:31], v[58:59], v[174:175], v[30:31] op_sel:[0,1,0] op_sel_hi:[1,1,1]
    s_waitcnt vmcnt(6)
    s_bitcmp1_b32 s79, 7
    s_cbranch_scc0 L_w40
    s_waitcnt vmcnt(4)
L_w40:
    buffer_load_dwordx4 v[92:95], v2, s[40:43], s61 offen offset:3072 nt
    s_add_u32 s60, s60, 0x10000
    s_add_u32 s61, s60, 4096
    s_waitcnt lgkmcnt(0)
    v_readfirstlane_b32 s79, v62
    v_add_u32 v46, 32, v46
    v_mov_b32 v48, v46
    ds_write_b32 v49, v46
    ds_read_b32 v62, v49 offset:16
    ds_read_b128 v[160:163], v5 offset:256
    ds_read_b128 v[164:167], v5 offset:288
    ds_read_b128 v[168:171], v5 offset:320
    ds_read_b128 v[172:175], v5 offset:352
    v_lshlrev_b32 v52, 16, v96
    v_and_b32 v53, s62, v96
    v_lshlrev_b32 v54, 16, v97
    v_and_b32 v55, s62, v97
    v_lshlrev_b32 v56, 16, v98
    v_and_b32 v57, s62, v98
    v_lshlrev_b32 v58, 16, v99
    v_and_b32 v59, s62, v99
    v_pk_fma_f32 v[16:17], v[52:53], v[176:177], v[16:17] op_sel:[0,0,0] op_sel_hi:[1,0,1]
    v_pk_fma_f32 v[18:19], v[54:55], v[176:177], v[18:19] op_sel:[0,0,0] op_sel_hi:[1,0,1]
    v_pk_fma_f32 v[20:21], v[56:57], v[176:177], v[20:21] op_sel:[0,0,0] op_sel_hi:[1,0,1]
    v_pk_fma_f32 v[22:23], v[58:59], v[176:177], v[22:23] op_sel:[0,0,0] op_sel_hi:[1,0,1]
    v_pk_fma_f32 v[24:25], v[52:53], v[176:177], v[24:25] op_sel:[0,1,0] op_sel_hi:[1,1,1]
    v_pk_fma_f32 v[26:27], v[54:55], v[176:177], v[26:27] op_sel:[0,1,0] op_sel_hi:[1,1,1]
    v_pk_fma_f32 v[28:29], v[56:57], v[176:177], v[28:29] op_sel:[0,1,0] op_sel_hi:[1,1,1]
    v_pk_fma_f32 v[30:31], v[58:59], v[176:177], v[30:31] op_sel:[0,1,0] op_sel_hi:[1,1,1]
    s_waitcnt vmcnt(6)
    s_bitcmp1_b32 s79, 8
    s_cbranch_scc0 L_w41
    s_waitcnt vmcnt(4)
L_w41:
    buffer_load_dwordx4 v[96:99], v2, s[40:43], s60 offen offset:0 nt
    v_lshlrev_b32 v52, 16, v100
    v_and_b32 v53, s62, v100
    v_lshlrev_b32 v54, 16, v101
    v_and_b32 v55, s62, v101
    v_lshlrev_b32 v56, 16, v102
    v_and_b32 v57, s62, v102
    v_lshlrev_b32 v58, 16, v103
    v_and_b32 v59, s62, v103
    v_pk_fma_f32 v[16:17], v[52:53], v[180:181], v[16:17] op_sel:[0,0,0] op_sel_hi:[1,0,1]
    v_pk_fma_f32 v[18:19], v[54:55], v[180:181], v[18:19] op_sel:[0,0,0] op_sel_hi:[1,0,1]
    v_pk_fma_f32 v[20:21], v[56:57], v[180:181], v[20:21] op_sel:[0,0,0] op_sel_hi:[1,0,1]
    v_pk_fma_f32 v[22:23], v[58:59], v[180:181], v[22:23] op_sel:[0,0,0] op_sel_hi:[1,0,1]
    v_pk_fma_f32 v[24:25], v[52:53], v[180:181], v[24:25] op_sel:[0,1,0] op_sel_hi:[1,1,1]
    v_pk_fma_f32 v[26:27], v[54:55], v[180:181], v[26:27] op_sel:[0,1,0] op_sel_hi:[1,1,1]
    v_pk_fma_f32 v[28:29], v[56:57], v[180:181], v[28:29] op_sel:[0,1,0] op_sel_hi:[1,1,1]
    v_pk_fma_f32 v[30:31], v[58:59], v[180:181], v[30:31] op_sel:[0,1,0] op_sel_hi:[1,1,1]
    s_waitcnt vmcnt(6)
    s_bitcmp1_b32 s79, 9
    s_cbranch_scc0 L_w42
    s_waitcnt vmcnt(4)
L_w42:
    buffer_load_dwordx4 v[100:103], v2, s[40:43], s60 offen offset:1024 nt
    v_add_u32 v48, 8, v48
    ds_write_b32 v49, v48
    v_lshlrev_b32 v52, 16, v104
    v_and_b32 v53, s62, v104
    v_lshlrev_b32 v54, 16, v105
    v_and_b32 v55, s62, v105
    v_lshlrev_b32 v56, 16, v106
    v_and_b32 v57, s62, v106
    v_lshlrev_b32 v58, 16, v107
    v_and_b32 v59, s62, v107
    v_pk_fma_f32 v[16:17], v[52:53], v[184:185], v[16:17] op_sel:[0,0,0] op_sel_hi:[1,0,1]
    v_pk_fma_f32 v[18:19], v[54:55], v[184:185], v[18:19] op_sel:[0,0,0] op_sel_hi:[1,0,1]
    v_pk_fma_f32 v[20:21], v[56:57], v[184:185], v[20:21] op_sel:[0,0,0] op_sel_hi:[1,0,1]
    v_pk_fma_f32 v[22:23], v[58:59], v[184:185], v[22:23] op_sel:[0,0,0] op_sel_hi:[1,0,1]
    v_pk_fma_f32 v[24:25], v[52:53], v[184:185], v[24:25] op_sel:[0,1,0] op_sel_hi:[1,1,1]
    v_pk_fma_f32 v[26:27], v[54:55], v[184:185], v[26:27] op_sel:[0,1,0] op_sel_hi:[1,1,1]
    v_pk_fma_f32 v[28:29], v[56:57], v[184:185], v[28:29] op_sel:[0,1,0] op_sel_hi:[1,1,1]
    v_pk_fma_f32 v[30:31], v[58:59], v[184:185], v[30:31] op_sel:[0,1,0] op_sel_hi:[1,1,1]
    s_waitcnt vmcnt(6)
    s_bitcmp1_b32 s79, 10
    s_cbranch_scc0 L_w43
    s_waitcnt vmcnt(4)
L_w43:
    buffer_load_dwordx4 v[104:107], v2, s[40:43], s60 offen offset:2048 nt
    v_lshlrev_b32 v52, 16, v108
    v_and_b32 v53, s62, v108
    v_lshlrev_b32 v54, 16, v109
    v_and_b32 v55, s62, v109
    v_lshlrev_b32 v56, 16, v110
    v_and_b32 v57, s62, v110
    v_lshlrev_b32 v58, 16, v111
    v_and_b32 v59, s62, v111
    v_pk_fma_f32 v[16:17], v[52:53], v[188:189], v[16:17] op_sel:[0,0,0] op_sel_hi:[1,0,1]
    v_pk_fma_f32 v[18:19], v[54:55], v[188:189], v[18:19] op_sel:[0,0,0] op_sel_hi:[1,0,1]
    v_pk_fma_f32 v[20:21], v[56:57], v[188:189], v[20:21] op_sel:[0,0,0] op_sel_hi:[1,0,1]
    v_pk_fma_f32 v[22:23], v[58:59], v[188:189], v[22:23] op_sel:[0,0,0] op_sel_hi:[1,0,1]
    v_pk_fma_f32 v[24:25], v[52:53], v[188:189], v[24:25] op_sel:[0,1,0] op_sel_hi:[1,1,1]
    v_pk_fma_f32 v[26:27], v[54:55], v[188:189], v[26:27] op_sel:[0,1,0] op_sel_hi:[1,1,1]
    v_pk_fma_f32 v[28:29], v[56:57], v[188:189], v[28:29] op_sel:[0,1,0] op_sel_hi:[1,1,1]
    v_pk_fma_f32 v[30:31], v[58:59], v[188:189], v[30:31] op_sel:[0,1,0] op_sel_hi:[1,1,1]
    s_waitcnt vmcnt(6)
    s_bitcmp1_b32 s79, 11
    s_cbranch_scc0 L_w44
    s_waitcnt vmcnt(4)
L_w44:
    buffer_load_dwordx4 v[108:111], v2, s[40:43], s60 offen offset:3072 nt
    v_add_u32 v48, 8, v48
    ds_write_b32 v49, v48
    v_lshlrev_b32 v52, 16, v112
    v_and_b32 v53, s62, v112
    v_lshlrev_b32 v54, 16, v113
    v_and_b32 v55, s62, v113
    v_lshlrev_b32 v56, 16, v114
    v_and_b32 v57, s62, v114
    v_lshlrev_b32 v58, 16, v115
    v_and_b32 v59, s62, v115
    v_pk_fma_f32 v[16:17], v[52:53], v[178:179], v[16:17] op_sel:[0,0,0] op_sel_hi:[1,0,1]
    v_pk_fma_f32 v[18:19], v[54:55], v[178:179], v[18:19] op_sel:[0,0,0] op_sel_hi:[1,0,1]
    v_pk_fma_f32 v[20:21], v[56:57], v[178:179], v[20:21] op_sel:[0,0,0] op_sel_hi:[1,0,1]
    v_pk_fma_f32 v[22:23], v[58:59], v[178:179], v[22:23] op_sel:[0,0,0] op_sel_hi:[1,0,1]
    v_pk_fma_f32 v[24:25], v[52:53], v[178:179], v[24:25] op_sel:[0,1,0] op_sel_hi:[1,1,1]
    v_pk_fma_f32 v[26:27], v[54:55], v[178:179], v[26:27] op_sel:[0,1,0] op_sel_hi:[1,1,1]
    v_pk_fma_f32 v[28:29], v[56:57], v[178:179], v[28:29] op_sel:[0,1,0] op_sel_hi:[1,1,1]
    v_pk_fma_f32 v[30:31], v[58:59], v[178:179], v[30:31] op_sel:[0,1,0] op_sel_hi:[1,1,1]
    s_waitcnt vmcnt(6)
    s_bitcmp1_b32 s79, 12
    s_cbranch_scc0 L_w45
    s_waitcnt vmcnt(4)
L_w45:
    buffer_load_dwordx4 v[112:115], v2, s[40:43], s61 offen offset:0 nt
    v_lshlrev_b32 v52, 16, v116
    v_and_b32 v53, s62, v116
    v_lshlrev_b32 v54, 16, v117
    v_and_b32 v55, s62, v117
    v_lshlrev_b32 v56, 16, v118
    v_and_b32 v57, s62, v118
    v_lshlrev_b32 v58, 16, v119
    v_and_b32 v59, s62, v119
    v_pk_fma_f32 v[16:17], v[52:53], v[182:183], v[16:17] op_sel:[0,0,0] op_sel_hi:[1,0,1]
    v_pk_fma_f32 v[18:19], v[54:55], v[182:183], v[18:19] op_sel:[0,0,0] op_sel_hi:[1,0,1]
    v_pk_fma_f32 v[20:21], v[56:57], v[182:183], v[20:21] op_sel:[0,0,0] op_sel_hi:[1,0,1]
    v_pk_fma_f32 v[22:23], v[58:59], v[182:183], v[22:23] op_sel:[0,0,0] op_sel_hi:[1,0,1]
    v_pk_fma_f32 v[24:25], v[52:53], v[182:183], v[24:25] op_sel:[0,1,0] op_sel_hi:[1,1,1]
    v_pk_fma_f32 v[26:27], v[54:55], v[182:183], v[26:27] op_sel:[0,1,0] op_sel_hi:[1,1,1]
    v_pk_fma_f32 v[28:29], v[56:57], v[182:183], v[28:29] op_sel:[0,1,0] op_sel_hi:[1,1,1]
    v_pk_fma_f32 v[30:31], v[58:59], v[182:183], v[30:31] op_sel:[0,1,0] op_sel_hi:[1,1,1]
    s_waitcnt vmcnt(6)
    s_bitcmp1_b32 s79, 13
    s_cbranch_scc0 L_w46
    s_waitcnt vmcnt(4)
L_w46:
    buffer_load_dwordx4 v[116:119], v2, s[40:43], s61 offen offset:1024 nt
    v_add_u32 v48, 8, v48
    ds_write_b32 v49, v48
    v_lshlrev_b32 v52, 16, v120
    v_and_b32 v53, s62, v120
    v_lshlrev_b32 v54, 16, v121
    v_and_b32 v55, s62, v121
    v_lshlrev_b32 v56, 16, v122
    v_and_b32 v57, s62, v122
    v_lshlrev_b32 v58, 16, v123
    v_and_b32 v59, s62, v123
    v_pk_fma_f32 v[16:17], v[52:53], v[186:187], v[16:17] op_sel:[0,0,0] op_sel_hi:[1,0,1]
    v_pk_fma_f32 v[18:19], v[54:55], v[186:187], v[18:19] op_sel:[0,0,0] op_sel_hi:[1,0,1]
    v_pk_fma_f32 v[20:21], v[56:57], v[186:187], v[20:21] op_sel:[0,0,0] op_sel_hi:[1,0,1]
    v_pk_fma_f32 v[22:23], v[58:59], v[186:187], v[22:23] op_sel:[0,0,0] op_sel_hi:[1,0,1]
    v_pk_fma_f32 v[24:25], v[52:53], v[186:187], v[24:25] op_sel:[0,1,0] op_sel_hi:[1,1,1]
    v_pk_fma_f32 v[26:27], v[54:55], v[186:187], v[26:27] op_sel:[0,1,0] op_sel_hi:[1,1,1]
    v_pk_fma_f32 v[28:29], v[56:57], v[186:187], v[28:29] op_sel:[0,1,0] op_sel_hi:[1,1,1]
    v_pk_fma_f32 v[30:31], v[58:59], v[186:187], v[30:31] op_sel:[0,1,0] op_sel_hi:[1,1,1]
    s_waitcnt vmcnt(6)
    s_bitcmp1_b32 s79, 14
    s_cbranch_scc0 L_w47
    s_waitcnt vmcnt(4)
L_w47:
    buffer_load_dwordx4 v[120:123], v2, s[40:43], s61 offen offset:2048 nt
    v_lshlrev_b32 v52, 16, v124
    v_and_b32 v53, s62, v124
    v_lshlrev_b32 v54, 16, v125
    v_and_b32 v55, s62, v125
    v_lshlrev_b32 v56, 16, v126
    v_and_b32 v57, s62, v126
    v_lshlrev_b32 v58, 16, v127
    v_and_b32 v59, s62, v127
    v_pk_fma_f32 v[16:17], v[52:53], v[190:191], v[16:17] op_sel:[0,0,0] op_sel_hi:[1,0,1]
    v_pk_fma_f32 v[18:19], v[54:55], v[190:191], v[18:19] op_sel:[0,0,0] op_sel_hi:[1,0,1]
    v_pk_fma_f32 v[20:21], v[56:57], v[190:191], v[20:21] op_sel:[0,0,0] op_sel_hi:[1,0,1]
    v_pk_fma_f32 v[22:23], v[58:59], v[190:191], v[22:23] op_sel:[0,0,0] op_sel_hi:[1,0,1]
    v_pk_fma_f32 v[24:25], v[52:53], v[190:191], v[24:25] op_sel:[0,1,0] op_sel_hi:[1,1,1]
    v_pk_fma_f32 v[26:27], v[54:55], v[190:191], v[26:27] op_sel:[0,1,0] op_sel_hi:[1,1,1]
    v_pk_fma_f32 v[28:29], v[56:57], v[190:191], v[28:29] op_sel:[0,1,0] op_sel_hi:[1,1,1]
    v_pk_fma_f32 v[30:31], v[58:59], v[190:191], v[30:31] op_sel:[0,1,0] op_sel_hi:[1,1,1]
    s_waitcnt vmcnt(6)
    s_bitcmp1_b32 s79, 15
    s_cbranch_scc0 L_w48
    s_waitcnt vmcnt(4)
L_w48:
    buffer_load_dwordx4 v[124:127], v2, s[40:43], s61 offen offset:3072 nt
    s_add_u32 s60, s60, 0x10000
    v_add_u32 v5, 256, v5
    s_add_u32 s59, s59, 1
    s_cmp_lt_u32 s59, 15
    s_cbranch_scc1 L_vloop
    s_waitcnt lgkmcnt(0)
    ds_read_b128 v[176:179], v5 offset:128
    ds_read_b128 v[180:183], v5 offset:160
    ds_read_b128 v[184:187], v5 offset:192
    ds_read_b128 v[188:191], v5 offset:224
    v_lshlrev_b32 v52, 16, v64
    v_and_b32 v53, s62, v64
    v_lshlrev_b32 v54, 16, v65
    v_and_b32 v55, s62, v65
    v_lshlrev_b32 v56, 16, v66
    v_and_b32 v57, s62, v66
    v_lshlrev_b32 v58, 16, v67
    v_and_b32 v59, s62, v67
    v_pk_fma_f32 v[16:17], v[52:53], v[160:161], v[16:17] op_sel:[0,0,0] op_sel_hi:[1,0,1]
    v_pk_fma_f32 v[18:19], v[54:55], v[160:161], v[18:19] op_sel:[0,0,0] op_sel_hi:[1,0,1]
    v_pk_fma_f32 v[20:21], v[56:57], v[160:161], v[20:21] op_sel:[0,0,0] op_sel_hi:[1,0,1]
    v_pk_fma_f32 v[22:23], v[58:59], v[160:161], v[22:23] op_sel:[0,0,0] op_sel_hi:[1,0,1]
    v_pk_fma_f32 v[24:25], v[52:53], v[160:161], v[24:25] op_sel:[0,1,0] op_sel_hi:[1,1,1]
    v_pk_fma_f32 v[26:27], v[54:55], v[160:161], v[26:27] op_sel:[0,1,0] op_sel_hi:[1,1,1]
    v_pk_fma_f32 v[28:29], v[56:57], v[160:161], v[28:29] op_sel:[0,1,0] op_sel_hi:[1,1,1]
    v_pk_fma_f32 v[30:31], v[58:59], v[160:161], v[30:31] op_sel:[0,1,0] op_sel_hi:[1,1,1]
    v_lshlrev_b32 v52, 16, v68
    v_and_b32 v53, s62, v68
    v_lshlrev_b32 v54, 16, v69
    v_and_b32 v55, s62, v69
    v_lshlrev_b32 v56, 16, v70
    v_and_b32 v57, s62, v70
    v_lshlrev_b32 v58, 16, v71
    v_and_b32 v59, s62, v71
    v_pk_fma_f32 v[16:17], v[52:53], v[164:165], v[16:17] op_sel:[0,0,0] op_sel_hi:[1,0,1]
    v_pk_fma_f32 v[18:19], v[54:55], v[164:165], v[18:19] op_sel:[0,0,0] op_sel_hi:[1,0,1]
    v_pk_fma_f32 v[20:21], v[56:57], v[164:165], v[20:21] op_sel:[0,0,0] op_sel_hi:[1,0,1]
    v_pk_fma_f32 v[22:23], v[58:59], v[164:165], v[22:23] op_sel:[0,0,0] op_sel_hi:[1,0,1]
    v_pk_fma_f32 v[24:25], v[52:53], v[164:165], v[24:25] op_sel:[0,1,0] op_sel_hi:[1,1,1]
    v_pk_fma_f32 v[26:27], v[54:55], v[164:165], v[26:27] op_sel:[0,1,0] op_sel_hi:[1,1,1]
    v_pk_fma_f32 v[28:29], v[56:57], v[164:165], v[28:29] op_sel:[0,1,0] op_sel_hi:[1,1,1]
    v_pk_fma_f32 v[30:31], v[58:59], v[164:165], v[30:31] op_sel:[0,1,0] op_sel_hi:[1,1,1]
    v_lshlrev_b32 v52, 16, v72
    v_and_b32 v53, s62, v72
    v_lshlrev_b32 v54, 16, v73
    v_and_b32 v55, s62, v73
    v_lshlrev_b32 v56, 16, v74
    v_and_b32 v57, s62, v74
    v_lshlrev_b32 v58, 16, v75
    v_and_b32 v59, s62, v75
    v_pk_fma_f32 v[16:17], v[52:53], v[168:169], v[16:17] op_sel:[0,0,0] op_sel_hi:[1,0,1]
    v_pk_fma_f32 v[18:19], v[54:55], v[168:169], v[18:19] op_sel:[0,0,0] op_sel_hi:[1,0,1]
    v_pk_fma_f32 v[20:21], v[56:57], v[168:169], v[20:21] op_sel:[0,0,0] op_sel_hi:[1,0,1]
    v_pk_fma_f32 v[22:23], v[58:59], v[168:169], v[22:23] op_sel:[0,0,0] op_sel_hi:[1,0,1]
    v_pk_fma_f32 v[24:25], v[52:53], v[168:169], v[24:25] op_sel:[0,1,0] op_sel_hi:[1,1,1]
    v_pk_fma_f32 v[26:27], v[54:55], v[168:169], v[26:27] op_sel:[0,1,0] op_sel_hi:[1,1,1]
    v_pk_fma_f32 v[28:29], v[56:57], v[168:169], v[28:29] op_sel:[0,1,0] op_sel_hi:[1,1,1]
    v_pk_fma_f32 v[30:31], v[58:59], v[168:169], v[30:31] op_sel:[0,1,0] op_sel_hi:[1,1,1]
    v_lshlrev_b32 v52, 16, v76
    v_and_b32 v53, s62, v76
    v_lshlrev_b32 v54, 16, v77
    v_and_b32 v55, s62, v77
    v_lshlrev_b32 v56, 16, v78
    v_and_b32 v57, s62, v78
    v_lshlrev_b32 v58, 16, v79
    v_and_b32 v59, s62, v79
    v_pk_fma_f32 v[16:17], v[52:53], v[172:173], v[16:17] op_sel:[0,0,0] op_sel_hi:[1,0,1]
    v_pk_fma_f32 v[18:19], v[54:55], v[172:173], v[18:19] op_sel:[0,0,0] op_sel_hi:[1,0,1]
    v_pk_fma_f32 v[20:21], v[56:57], v[172:173], v[20:21] op_sel:[0,0,0] op_sel_hi:[1,0,1]
    v_pk_fma_f32 v[22:23], v[58:59], v[172:173], v[22:23] op_sel:[0,0,0] op_sel_hi:[1,0,1]
    v_pk_fma_f32 v[24:25], v[52:53], v[172:173], v[24:25] op_sel:[0,1,0] op_sel_hi:[1,1,1]
    v_pk_fma_f32 v[26:27], v[54:55], v[172:173], v[26:27] op_sel:[0,1,0] op_sel_hi:[1,1,1]
    v_pk_fma_f32 v[28:29], v[56:57], v[172:173], v[28:29] op_sel:[0,1,0] op_sel_hi:[1,1,1]
    v_pk_fma_f32 v[30:31], v[58:59], v[172:173], v[30:31] op_sel:[0,1,0] op_sel_hi:[1,1,1]
    v_lshlrev_b32 v52, 16, v80
    v_and_b32 v53, s62, v80
    v_lshlrev_b32 v54, 16, v81
    v_and_b32 v55, s62, v81
    v_lshlrev_b32 v56, 16, v82
    v_and_b32 v57, s62, v82
    v_lshlrev_b32 v58, 16, v83
    v_and_b32 v59, s62, v83
    v_pk_fma_f32 v[16:17], v[52:53], v[162:163], v[16:17] op_sel:[0,0,0] op_sel_hi:[1,0,1]
    v_pk_fma_f32 v[18:19], v[54:55], v[162:163], v[18:19] op_sel:[0,0,0] op_sel_hi:[1,0,1]
    v_pk_fma_f32 v[20:21], v[56:57], v[162:163], v[20:21] op_sel:[0,0,0] op_sel_hi:[1,0,1]
    v_pk_fma_f32 v[22:23], v[58:59], v[162:163], v[22:23] op_sel:[0,0,0] op_sel_hi:[1,0,1]
    v_pk_fma_f32 v[24:25], v[52:53], v[162:163], v[24:25] op_sel:[0,1,0] op_sel_hi:[1,1,1]
    v_pk_fma_f32 v[26:27], v[54:55], v[162:163], v[26:27] op_sel:[0,1,0] op_sel_hi:[1,1,1]
    v_pk_fma_f32 v[28:29], v[56:57], v[162:163], v[28:29] op_sel:[0,1,0] op_sel_hi:[1,1,1]
    v_pk_fma_f32 v[30:31], v[58:59], v[162:163], v[30:31] op_sel:[0,1,0] op_sel_hi:[1,1,1]
    v_lshlrev_b32 v52, 16, v84
    v_and_b32 v53, s62, v84
    v_lshlrev_b32 v54, 16, v85
    v_and_b32 v55, s62, v85
    v_lshlrev_b32 v56, 16, v86
    v_and_b32 v57, s62, v86
    v_lshlrev_b32 v58, 16, v87
    v_and_b32 v59, s62, v87
    v_pk_fma_f32 v[16:17], v[52:53], v[166:167], v[16:17] op_sel:[0,0,0] op_sel_hi:[1,0,1]
    v_pk_fma_f32 v[18:19], v[54:55], v[166:167], v[18:19] op_sel:[0,0,0] op_sel_hi:[1,0,1]
    v_pk_fma_f32 v[20:21], v[56:57], v[166:167], v[20:21] op_sel:[0,0,0] op_sel_hi:[1,0,1]
    v_pk_fma_f32 v[22:23], v[58:59], v[166:167], v[22:23] op_sel:[0,0,0] op_sel_hi:[1,0,1]
    v_pk_fma_f32 v[24:25], v[52:53], v[166:167], v[24:25] op_sel:[0,1,0] op_sel_hi:[1,1,1]
    v_pk_fma_f32 v[26:27], v[54:55], v[166:167], v[26:27] op_sel:[0,1,0] op_sel_hi:[1,1,1]
    v_pk_fma_f32 v[28:29], v[56:57], v[166:167], v[28:29] op_sel:[0,1,0] op_sel_hi:[1,1,1]
    v_pk_fma_f32 v[30:31], v[58:59], v[166:167], v[30:31] op_sel:[0,1,0] op_sel_hi:[1,1,1]
    v_lshlrev_b32 v52, 16, v88
    v_and_b32 v53, s62, v88
    v_lshlrev_b32 v54, 16, v89
    v_and_b32 v55, s62, v89
    v_lshlrev_b32 v56, 16, v90
    v_and_b32 v57, s62, v90
    v_lshlrev_b32 v58, 16, v91
    v_and_b32 v59, s62, v91
    v_pk_fma_f32 v[16:17], v[52:53], v[170:171], v[16:17] op_sel:[0,0,0] op_sel_hi:[1,0,1]
    v_pk_fma_f32 v[18:19], v[54:55], v[170:171], v[18:19] op_sel:[0,0,0] op_sel_hi:[1,0,1]
    v_pk_fma_f32 v[20:21], v[56:57], v[170:171], v[20:21] op_sel:[0,0,0] op_sel_hi:[1,0,1]
    v_pk_fma_f32 v[22:23], v[58:59], v[170:171], v[22:23] op_sel:[0,0,0] op_sel_hi:[1,0,1]
    v_pk_fma_f32 v[24:25], v[52:53], v[170:171], v[24:25] op_sel:[0,1,0] op_sel_hi:[1,1,1]
    v_pk_fma_f32 v[26:27], v[54:55], v[170:171], v[26:27] op_sel:[0,1,0] op_sel_hi:[1,1,1]
    v_pk_fma_f32 v[28:29], v[56:57], v[170:171], v[28:29] op_sel:[0,1,0] op_sel_hi:[1,1,1]
    v_pk_fma_f32 v[30:31], v[58:59], v[170:171], v[30:31] op_sel:[0,1,0] op_sel_hi:[1,1,1]
    v_lshlrev_b32 v52, 16, v92
    v_and_b32 v53, s62, v92
    v_lshlrev_b32 v54, 16, v93
    v_and_b32 v55, s62, v93
    v_lshlrev_b32 v56, 16, v94
    v_and_b32 v57, s62, v94
    v_lshlrev_b32 v58, 16, v95
    v_and_b32 v59, s62, v95
    v_pk_fma_f32 v[16:17], v[52:53], v[174:175], v[16:17] op_sel:[0,0,0] op_sel_hi:[1,0,1]
    v_pk_fma_f32 v[18:19], v[54:55], v[174:175], v[18:19] op_sel:[0,0,0] op_sel_hi:[1,0,1]
    v_pk_fma_f32 v[20:21], v[56:57], v[174:175], v[20:21] op_sel:[0,0,0] op_sel_hi:[1,0,1]
    v_pk_fma_f32 v[22:23], v[58:59], v[174:175], v[22:23] op_sel:[0,0,0] op_sel_hi:[1,0,1]
    v_pk_fma_f32 v[24:25], v[52:53], v[174:175], v[24:25] op_sel:[0,1,0] op_sel_hi:[1,1,1]
    v_pk_fma_f32 v[26:27], v[54:55], v[174:175], v[26:27] op_sel:[0,1,0] op_sel_hi:[1,1,1]
    v_pk_fma_f32 v[28:29], v[56:57], v[174:175], v[28:29] op_sel:[0,1,0] op_sel_hi:[1,1,1]
    v_pk_fma_f32 v[30:31], v[58:59], v[174:175], v[30:31] op_sel:[0,1,0] op_sel_hi:[1,1,1]
    s_waitcnt lgkmcnt(0)
    v_lshlrev_b32 v52, 16, v96
    v_and_b32 v53, s62, v96
    v_lshlrev_b32 v54, 16, v97
    v_and_b32 v55, s62, v97
    v_lshlrev_b32 v56, 16, v98
    v_and_b32 v57, s62, v98
    v_lshlrev_b32 v58, 16, v99
    v_and_b32 v59, s62, v99
    v_pk_fma_f32 v[16:17], v[52:53], v[176:177], v[16:17] op_sel:[0,0,0] op_sel_hi:[1,0,1]
    v_pk_fma_f32 v[18:19], v[54:55], v[176:177], v[18:19] op_sel:[0,0,0] op_sel_hi:[1,0,1]
    v_pk_fma_f32 v[20:21], v[56:57], v[176:177], v[20:21] op_sel:[0,0,0] op_sel_hi:[1,0,1]
    v_pk_fma_f32 v[22:23], v[58:59], v[176:177], v[22:23] op_sel:[0,0,0] op_sel_hi:[1,0,1]
    v_pk_fma_f32 v[24:25], v[52:53], v[176:177], v[24:25] op_sel:[0,1,0] op_sel_hi:[1,1,1]
    v_pk_fma_f32 v[26:27], v[54:55], v[176:177], v[26:27] op_sel:[0,1,0] op_sel_hi:[1,1,1]
    v_pk_fma_f32 v[28:29], v[56:57], v[176:177], v[28:29] op_sel:[0,1,0] op_sel_hi:[1,1,1]
    v_pk_fma_f32 v[30:31], v[58:59], v[176:177], v[30:31] op_sel:[0,1,0] op_sel_hi:[1,1,1]
    s_waitcnt vmcnt(6)
    v_lshlrev_b32 v52, 16, v100
    v_and_b32 v53, s62, v100
    v_lshlrev_b32 v54, 16, v101
    v_and_b32 v55, s62, v101
    v_lshlrev_b32 v56, 16, v102
    v_and_b32 v57, s62, v102
    v_lshlrev_b32 v58, 16, v103
    v_and_b32 v59, s62, v103
    v_pk_fma_f32 v[16:17], v[52:53], v[180:181], v[16:17] op_sel:[0,0,0] op_sel_hi:[1,0,1]
    v_pk_fma_f32 v[18:19], v[54:55], v[180:181], v[18:19] op_sel:[0,0,0] op_sel_hi:[1,0,1]
    v_pk_fma_f32 v[20:21], v[56:57], v[180:181], v[20:21] op_sel:[0,0,0] op_sel_hi:[1,0,1]
    v_pk_fma_f32 v[22:23], v[58:59], v[180:181], v[22:23] op_sel:[0,0,0] op_sel_hi:[1,0,1]
    v_pk_fma_f32 v[24:25], v[52:53], v[180:181], v[24:25] op_sel:[0,1,0] op_sel_hi:[1,1,1]
    v_pk_fma_f32 v[26:27], v[54:55], v[180:181], v[26:27] op_sel:[0,1,0] op_sel_hi:[1,1,1]
    v_pk_fma_f32 v[28:29], v[56:57], v[180:181], v[28:29] op_sel:[0,1,0] op_sel_hi:[1,1,1]
    v_pk_fma_f32 v[30:31], v[58:59], v[180:181], v[30:31] op_sel:[0,1,0] op_sel_hi:[1,1,1]
    s_waitcnt vmcnt(5)
    v_lshlrev_b32 v52, 16, v104
    v_and_b32 v53, s62, v104
    v_lshlrev_b32 v54, 16, v105
    v_and_b32 v55, s62, v105
    v_lshlrev_b32 v56, 16, v106
    v_and_b32 v57, s62, v106
    v_lshlrev_b32 v58, 16, v107
    v_and_b32 v59, s62, v107
    v_pk_fma_f32 v[16:17], v[52:53], v[184:185], v[16:17] op_sel:[0,0,0] op_sel_hi:[1,0,1]
    v_pk_fma_f32 v[18:19], v[54:55], v[184:185], v[18:19] op_sel:[0,0,0] op_sel_hi:[1,0,1]
    v_pk_fma_f32 v[20:21], v[56:57], v[184:185], v[20:21] op_sel:[0,0,0] op_sel_hi:[1,0,1]
    v_pk_fma_f32 v[22:23], v[58:59], v[184:185], v[22:23] op_sel:[0,0,0] op_sel_hi:[1,0,1]
    v_pk_fma_f32 v[24:25], v[52:53], v[184:185], v[24:25] op_sel:[0,1,0] op_sel_hi:[1,1,1]
    v_pk_fma_f32 v[26:27], v[54:55], v[184:185], v[26:27] op_sel:[0,1,0] op_sel_hi:[1,1,1]
    v_pk_fma_f32 v[28:29], v[56:57], v[184:185], v[28:29] op_sel:[0,1,0] op_sel_hi:[1,1,1]
    v_pk_fma_f32 v[30:31], v[58:59], v[184:185], v[30:31] op_sel:[0,1,0] op_sel_hi:[1,1,1]
    s_waitcnt vmcnt(4)
    v_lshlrev_b32 v52, 16, v108
    v_and_b32 v53, s62, v108
    v_lshlrev_b32 v54, 16, v109
    v_and_b32 v55, s62, v109
    v_lshlrev_b32 v56, 16, v110
    v_and_b32 v57, s62, v110
    v_lshlrev_b32 v58, 16, v111
    v_and_b32 v59, s62, v111
    v_pk_fma_f32 v[16:17], v[52:53], v[188:189], v[16:17] op_sel:[0,0,0] op_sel_hi:[1,0,1]
    v_pk_fma_f32 v[18:19], v[54:55], v[188:189], v[18:19] op_sel:[0,0,0] op_sel_hi:[1,0,1]
    v_pk_fma_f32 v[20:21], v[56:57], v[188:189], v[20:21] op_sel:[0,0,0] op_sel_hi:[1,0,1]
    v_pk_fma_f32 v[22:23], v[58:59], v[188:189], v[22:23] op_sel:[0,0,0] op_sel_hi:[1,0,1]
    v_pk_fma_f32 v[24:25], v[52:53], v[188:189], v[24:25] op_sel:[0,1,0] op_sel_hi:[1,1,1]
    v_pk_fma_f32 v[26:27], v[54:55], v[188:189], v[26:27] op_sel:[0,1,0] op_sel_hi:[1,1,1]
    v_pk_fma_f32 v[28:29], v[56:57], v[188:189], v[28:29] op_sel:[0,1,0] op_sel_hi:[1,1,1]
    v_pk_fma_f32 v[30:31], v[58:59], v[188:189], v[30:31] op_sel:[0,1,0] op_sel_hi:[1,1,1]
    s_waitcnt vmcnt(3)
    v_lshlrev_b32 v52, 16, v112
    v_and_b32 v53, s62, v112
    v_lshlrev_b32 v54, 16, v113
    v_and_b32 v55, s62, v113
    v_lshlrev_b32 v56, 16, v114
    v_and_b32 v57, s62, v114
    v_lshlrev_b32 v58, 16, v115
    v_and_b32 v59, s62, v115
    v_pk_fma_f32 v[16:17], v[52:53], v[178:179], v[16:17] op_sel:[0,0,0] op_sel_hi:[1,0,1]
    v_pk_fma_f32 v[18:19], v[54:55], v[178:179], v[18:19] op_sel:[0,0,0] op_sel_hi:[1,0,1]
    v_pk_fma_f32 v[20:21], v[56:57], v[178:179], v[20:21] op_sel:[0,0,0] op_sel_hi:[1,0,1]
    v_pk_fma_f32 v[22:23], v[58:59], v[178:179], v[22:23] op_sel:[0,0,0] op_sel_hi:[1,0,1]
    v_pk_fma_f32 v[24:25], v[52:53], v[178:179], v[24:25] op_sel:[0,1,0] op_sel_hi:[1,1,1]
    v_pk_fma_f32 v[26:27], v[54:55], v[178:179], v[26:27] op_sel:[0,1,0] op_sel_hi:[1,1,1]
    v_pk_fma_f32 v[28:29], v[56:57], v[178:179], v[28:29] op_sel:[0,1,0] op_sel_hi:[1,1,1]
    v_pk_fma_f32 v[30:31], v[58:59], v[178:179], v[30:31] op_sel:[0,1,0] op_sel_hi:[1,1,1]
    s_waitcnt vmcnt(2)
    v_lshlrev_b32 v52, 16, v116
    v_and_b32 v53, s62, v116
    v_lshlrev_b32 v54, 16, v117
    v_and_b32 v55, s62, v117
    v_lshlrev_b32 v56, 16, v118
    v_and_b32 v57, s62, v118
    v_lshlrev_b32 v58, 16, v119
    v_and_b32 v59, s62, v119
    v_pk_fma_f32 v[16:17], v[52:53], v[182:183], v[16:17] op_sel:[0,0,0] op_sel_hi:[1,0,1]
    v_pk_fma_f32 v[18:19], v[54:55], v[182:183], v[18:19] op_sel:[0,0,0] op_sel_hi:[1,0,1]
    v_pk_fma_f32 v[20:21], v[56:57], v[182:183], v[20:21] op_sel:[0,0,0] op_sel_hi:[1,0,1]
    v_pk_fma_f32 v[22:23], v[58:59], v[182:183], v[22:23] op_sel:[0,0,0] op_sel_hi:[1,0,1]
    v_pk_fma_f32 v[24:25], v[52:53], v[182:183], v[24:25] op_sel:[0,1,0] op_sel_hi:[1,1,1]
    v_pk_fma_f32 v[26:27], v[54:55], v[182:183], v[26:27] op_sel:[0,1,0] op_sel_hi:[1,1,1]
    v_pk_fma_f32 v[28:29], v[56:57], v[182:183], v[28:29] op_sel:[0,1,0] op_sel_hi:[1,1,1]
    v_pk_fma_f32 v[30:31], v[58:59], v[182:183], v[30:31] op_sel:[0,1,0] op_sel_hi:[1,1,1]
    s_waitcnt vmcnt(1)
    v_lshlrev_b32 v52, 16, v120
    v_and_b32 v53, s62, v120
    v_lshlrev_b32 v54, 16, v121
    v_and_b32 v55, s62, v121
    v_lshlrev_b32 v56, 16, v122
    v_and_b32 v57, s62, v122
    v_lshlrev_b32 v58, 16, v123
    v_and_b32 v59, s62, v123
    v_pk_fma_f32 v[16:17], v[52:53], v[186:187], v[16:17] op_sel:[0,0,0] op_sel_hi:[1,0,1]
    v_pk_fma_f32 v[18:19], v[54:55], v[186:187], v[18:19] op_sel:[0,0,0] op_sel_hi:[1,0,1]
    v_pk_fma_f32 v[20:21], v[56:57], v[186:187], v[20:21] op_sel:[0,0,0] op_sel_hi:[1,0,1]
    v_pk_fma_f32 v[22:23], v[58:59], v[186:187], v[22:23] op_sel:[0,0,0] op_sel_hi:[1,0,1]
    v_pk_fma_f32 v[24:25], v[52:53], v[186:187], v[24:25] op_sel:[0,1,0] op_sel_hi:[1,1,1]
    v_pk_fma_f32 v[26:27], v[54:55], v[186:187], v[26:27] op_sel:[0,1,0] op_sel_hi:[1,1,1]
    v_pk_fma_f32 v[28:29], v[56:57], v[186:187], v[28:29] op_sel:[0,1,0] op_sel_hi:[1,1,1]
    v_pk_fma_f32 v[30:31], v[58:59], v[186:187], v[30:31] op_sel:[0,1,0] op_sel_hi:[1,1,1]
    s_waitcnt vmcnt(0)
    v_lshlrev_b32 v52, 16, v124
    v_and_b32 v53, s62, v124
    v_lshlrev_b32 v54, 16, v125
    v_and_b32 v55, s62, v125
    v_lshlrev_b32 v56, 16, v126
    v_and_b32 v57, s62, v126
    v_lshlrev_b32 v58, 16, v127
    v_and_b32 v59, s62, v127
    v_pk_fma_f32 v[16:17], v[52:53], v[190:191], v[16:17] op_sel:[0,0,0] op_sel_hi:[1,0,1]
    v_pk_fma_f32 v[18:19], v[54:55], v[190:191], v[18:19] op_sel:[0,0,0] op_sel_hi:[1,0,1]
    v_pk_fma_f32 v[20:21], v[56:57], v[190:191], v[20:21] op_sel:[0,0,0] op_sel_hi:[1,0,1]
    v_pk_fma_f32 v[22:23], v[58:59], v[190:191], v[22:23] op_sel:[0,0,0] op_sel_hi:[1,0,1]
    v_pk_fma_f32 v[24:25], v[52:53], v[190:191], v[24:25] op_sel:[0,1,0] op_sel_hi:[1,1,1]
    v_pk_fma_f32 v[26:27], v[54:55], v[190:191], v[26:27] op_sel:[0,1,0] op_sel_hi:[1,1,1]
    v_pk_fma_f32 v[28:29], v[56:57], v[190:191], v[28:29] op_sel:[0,1,0] op_sel_hi:[1,1,1]
    v_pk_fma_f32 v[30:31], v[58:59], v[190:191], v[30:31] op_sel:[0,1,0] op_sel_hi:[1,1,1]
    s_nop 1
    v_permlane32_swap_b32 v16, v24
    v_permlane32_swap_b32 v17, v25
    v_permlane32_swap_b32 v18, v26
    v_permlane32_swap_b32 v19, v27
    v_permlane32_swap_b32 v20, v28
    v_permlane32_swap_b32 v21, v29
    v_permlane32_swap_b32 v22, v30
    v_permlane32_swap_b32 v23, v31
    v_add_f32 v16, v16, v24
    v_add_f32 v17, v17, v25
    v_add_f32 v18, v18, v26
    v_add_f32 v19, v19, v27
    v_add_f32 v20, v20, v28
    v_add_f32 v21, v21, v29
    v_add_f32 v22, v22, v30
    v_add_f32 v23, v23, v31
    ds_write_b128 v9, v[16:19]
    ds_write_b128 v9, v[20:23] offset:16
    s_waitcnt lgkmcnt(0)
    s_barrier
    ds_read_b128 v[64:67], v10 offset:0
    ds_read_b128 v[68:71], v10 offset:2048
    ds_read_b128 v[72:75], v10 offset:4096
    ds_read_b128 v[76:79], v10 offset:6144
    ds_read_b128 v[88:91], v60
    s_waitcnt lgkmcnt(0)
    v_pk_mul_f32 v[80:81], v[64:65], v[88:89] op_sel:[0,0] op_sel_hi:[1,0]
    v_pk_mul_f32 v[82:83], v[66:67], v[88:89] op_sel:[0,0] op_sel_hi:[1,0]
    v_pk_fma_f32 v[80:81], v[68:69], v[88:89], v[80:81] op_sel:[0,1,0] op_sel_hi:[1,1,1]
    v_pk_fma_f32 v[82:83], v[70:71], v[88:89], v[82:83] op_sel:[0,1,0] op_sel_hi:[1,1,1]
    v_pk_fma_f32 v[80:81], v[72:73], v[90:91], v[80:81] op_sel:[0,0,0] op_sel_hi:[1,0,1]
    v_pk_fma_f32 v[82:83], v[74:75], v[90:91], v[82:83] op_sel:[0,0,0] op_sel_hi:[1,0,1]
    v_pk_fma_f32 v[80:81], v[76:77], v[90:91], v[80:81] op_sel:[0,1,0] op_sel_hi:[1,1,1]
    v_pk_fma_f32 v[82:83], v[78:79], v[90:91], v[82:83] op_sel:[0,1,0] op_sel_hi:[1,1,1]
    v_perm_b32 v92, v80, v83, s48
    v_perm_b32 v93, v81, v83, s49
    v_perm_b32 v94, v82, v83, s50
    v_bitop3_b32 v95, v92, v93, v94 bitop3:0x96
    v_xor_b32 v95, s58, v95
    s_mov_b32 exec_hi, 0
    buffer_store_dwordx4 v[92:95], v6, s[36:39], 0 offen sc1
    s_mov_b32 exec_hi, -1
    s_barrier
    ds_read_b128 v[100:103], v3
    ds_read_b32 v104, v63 offset:4
    s_waitcnt lgkmcnt(0)
    s_barrier
    ds_read_b64_tr_b16 v[128:129], v11 offset:0
    ds_read_b64_tr_b16 v[130:131], v11 offset:3584
    ds_read_b64_tr_b16 v[132:133], v11 offset:32
    ds_read_b64_tr_b16 v[134:135], v11 offset:3616
    ds_read_b64_tr_b16 v[136:137], v11 offset:64
    ds_read_b64_tr_b16 v[138:139], v11 offset:3648
    ds_read_b64_tr_b16 v[140:141], v11 offset:96
    ds_read_b64_tr_b16 v[142:143], v11 offset:3680
    ds_read_b64_tr_b16 v[144:145], v11 offset:128
    ds_read_b64_tr_b16 v[146:147], v11 offset:3712
    ds_read_b64_tr_b16 v[148:149], v11 offset:160
    ds_read_b64_tr_b16 v[150:151], v11 offset:3744
    ds_read_b64_tr_b16 v[152:153], v11 offset:192
    ds_read_b64_tr_b16 v[154:155], v11 offset:3776
    s_waitcnt lgkmcnt(0)
    s_barrier
    ds_read_b128 v[160:163], v7 offset:384
    ds_read_b128 v[164:167], v7 offset:320
    ds_read_b128 v[168:171], v7 offset:256
    ds_read_b128 v[172:175], v7 offset:192
    ds_read_b128 v[176:179], v7 offset:128
    ds_read_b128 v[180:183], v7 offset:64
    ds_read_b128 v[184:187], v7 offset:0
    s_waitcnt lgkmcnt(6)
    v_mfma_f32_16x16x32_bf16 v[96:99], v[128:131], v[160:163], 0
    s_waitcnt lgkmcnt(5)
    v_mfma_f32_16x16x32_bf16 v[96:99], v[132:135], v[164:167], v[96:99]
    s_waitcnt lgkmcnt(4)
    v_mfma_f32_16x16x32_bf16 v[96:99], v[136:139], v[168:171], v[96:99]
    s_waitcnt lgkmcnt(3)
    v_mfma_f32_16x16x32_bf16 v[96:99], v[140:143], v[172:175], v[96:99]
    s_waitcnt lgkmcnt(2)
    v_mfma_f32_16x16x32_bf16 v[96:99], v[144:147], v[176:179], v[96:99]
    s_waitcnt lgkmcnt(1)
    v_mfma_f32_16x16x32_bf16 v[96:99], v[148:151], v[180:183], v[96:99]
    s_waitcnt lgkmcnt(0)
    v_mfma_f32_16x16x32_bf16 v[96:99], v[152:155], v[184:187], v[96:99]
    s_nop 7
    v_fma_f32 v96, v96, v104, v100
    v_fma_f32 v97, v97, v104, v101
    v_fma_f32 v98, v98, v104, v102
    v_fma_f32 v99, v99, v104, v103
    v_perm_b32 v108, v96, v99, s48
    v_perm_b32 v109, v97, v99, s49
    v_perm_b32 v110, v98, v99, s50
    v_bitop3_b32 v111, v108, v109, v110 bitop3:0x96
    v_xor_b32 v111, s58, v111
    s_mov_b64 exec, s[64:65]
    buffer_store_dwordx4 v[108:111], v8, s[36:39], 0 offen sc1
    s_mov_b64 exec, -1
    s_cmp_ge_u32 s44, 28
    s_cbranch_scc1 L_send
    s_waitcnt vmcnt(0)
    s_mov_b32 s70, 0x40000
L_poll49:
    buffer_load_dwordx4 v[112:115], v44, s[36:39], 0 offen sc1
    buffer_load_dwordx4 v[116:119], v44, s[36:39], s45 offen sc1
    s_waitcnt vmcnt(0)
    v_bitop3_b32 v120, v112, v113, v114 bitop3:0x96
    v_xor_b32 v120, v120, v115
    v_cmp_ne_u32_e64 s[72:73], s58, v120
    v_bitop3_b32 v121, v116, v117, v118 bitop3:0x96
    v_xor_b32 v121, v121, v119
    v_cmp_ne_u32_e64 s[74:75], s58, v121
    s_or_b64 s[72:73], s[72:73], s[74:75]
    s_cmp_eq_u64 s[72:73], 0
    s_cbranch_scc1 L_pdone50
    s_mov_b64 exec, s[72:73]
    s_sub_u32 s70, s70, 1
    s_cmp_lg_u32 s70, 0
    s_cbranch_scc1 L_poll49
L_pdone50:
    s_mov_b64 exec, -1
    v_perm_b32 v115, v114, v113, s46
    v_perm_b32 v119, v118, v117, s46
    v_perm_b32 v115, v115, v112, s47
    v_perm_b32 v119, v119, v116, s47
    v_add_f32 v112, v112, v116
    v_add_f32 v113, v113, v117
    v_add_f32 v114, v114, v118
    v_add_f32 v115, v115, v119
    s_nop 1
    v_permlane32_swap_b32 v112, v114
    v_permlane32_swap_b32 v113, v115
    s_nop 0
    v_add_f32 v112, v112, v114
    v_add_f32 v113, v113, v115
    s_nop 1
    v_permlane16_swap_b32 v112, v113
    s_nop 0
    v_add_f32 v112, v112, v113
    s_nop 1
    v_add_f32_dpp v112, v112, v112 row_ror:8 row_mask:0xf bank_mask:0xf
    s_nop 1
    v_add_f32_dpp v112, v112, v112 row_ror:4 row_mask:0xf bank_mask:0xf
    ds_write_b32 v45, v112
    s_waitcnt lgkmcnt(0)
L_send:
    s_endpgm
L_end:
    s_endpgm
.section .rodata,"a"
.p2align 6
.amdhsa_kernel gated_mix__gqa_block_cached__glu_gated_swiglu__decode_kernel
  .amdhsa_next_free_vgpr 256
  .amdhsa_next_free_sgpr 102
  .amdhsa_accum_offset 256
  .amdhsa_group_segment_fixed_size 0
  .amdhsa_kernarg_size 104
  .amdhsa_user_sgpr_count 2
  .amdhsa_user_sgpr_kernarg_segment_ptr 1
  .amdhsa_system_sgpr_workgroup_id_x 1
  .amdhsa_float_denorm_mode_32 3
.end_amdhsa_kernel
```
